```python
import torch

def _softmax(x, axis=-1):
    return torch.softmax(x, dim=axis)
def _gelu(x):
    return torch.nn.functional.gelu(x, approximate="tanh")
def _silu(x):
    return torch.nn.functional.silu(x)
def _sigmoid(x):
    return torch.sigmoid(x)
def _layernorm(x, axis=-1, eps=1e-5):
    m = x.mean(dim=axis, keepdim=True)
    v = x.var(dim=axis, keepdim=True, unbiased=False)
    return (x - m) / torch.sqrt(v + eps)
def _scatter_add(tgt, idx, src, axis=0):
    return tgt.clone().index_add_(axis, idx, src)
def _segment_sum(src, seg, n):
    out = torch.zeros((n,) + src.shape[1:], dtype=src.dtype)
    return out.index_add_(0, seg, src)
def _pad(x, pw):
    flat = tuple(v for pair in reversed(pw) for v in pair)
    return torch.nn.functional.pad(x, flat)

kernel_name = 'sequential_preLN__mha_block_cached__swiglu_ffn__decode'

def setup_inputs():

    _w = (lambda a: (lambda t: t.to(torch.bfloat16) if t.is_floating_point() else t)(torch.as_tensor(a)))
    def _A_setup():
        B, Sq, D = 8, 1, 512
        H, Sk, Dh = 32, 4096, 128
        return {
            "x": _w((lambda *s: torch.randn(*s, dtype=torch.bfloat16) * 0.05)(B, Sq, D)),
            "k_cache": _w((lambda *s: torch.randn(*s, dtype=torch.bfloat16) * 3.2)(B, H, Sk, Dh)),
            "v_cache": _w((lambda *s: torch.randn(*s, dtype=torch.bfloat16) * 0.4)(B, H, Sk, Dh)),
            "wq": _w((lambda *s: torch.randn(*s, dtype=torch.bfloat16) * 3.2)(D, H * Dh) * (D ** -0.5)),
            "wo": _w((lambda *s: torch.randn(*s, dtype=torch.bfloat16) * 0.4)(H * Dh, D) * ((H * Dh) ** -0.5)),
        }
    _A_in = _A_setup()

    def _B_setup():
        B, S, D, F = 8, 1, 512, 1376
        return {
            "x": _w((lambda *s: torch.randn(*s, dtype=torch.bfloat16) * 0.05)(B, S, D)),
            "w_gate": _w((lambda *s: torch.randn(*s, dtype=torch.bfloat16) * 0.05)(D, F)),
            "w_up": _w((lambda *s: torch.randn(*s, dtype=torch.bfloat16) * 0.05)(D, F)),
            "w_down": _w((lambda *s: torch.randn(*s, dtype=torch.bfloat16) * 0.05)(F, D)),
        }
    _B_in = _B_setup()

    return {
        "A_x": _A_in["x"],
        "A_k_cache": _A_in["k_cache"],
        "A_v_cache": _A_in["v_cache"],
        "A_wq": _A_in["wq"],
        "A_wo": _A_in["wo"],
        "B_x": _B_in["x"],
        "B_w_gate": _B_in["w_gate"],
        "B_w_up": _B_in["w_up"],
        "B_w_down": _B_in["w_down"],
    }

def reference(A_x, A_k_cache, A_v_cache, A_wq, A_wo, B_x, B_w_gate, B_w_up, B_w_down):
    def _A_ref(x, k_cache, v_cache, wq, wo):
        B, Sq, D = x.shape
        H, Dh = 32, 128
        q = (lambda x, *d: x.permute(*d))((x @ wq).reshape(B, Sq, H, Dh), 0, 2, 1, 3)
        scores = torch.einsum("bhqd,bhkd->bhqk", q, k_cache) * (Dh ** -0.5)
        p = _softmax(scores, axis=-1)
        o = torch.einsum("bhqk,bhkd->bhqd", p, v_cache)
        return (lambda x, *d: x.permute(*d))(o, 0, 2, 1, 3).reshape(B, Sq, H * Dh) @ wo

    def _B_ref(x, w_gate, w_up, w_down):
        g = _silu(x @ w_gate)
        u = x @ w_up
        return (g * u) @ w_down

    x = A_x
    h = x + _A_ref(_layernorm(x, axis=-1), A_k_cache, A_v_cache, A_wq, A_wo)
    h2 = h + _B_ref(_layernorm(h, axis=-1), B_w_gate, B_w_up, B_w_down)
    return h2
```

```asm
; @launch grid=(256,1,1) block=(1024,1,1) lds=49664
.amdgcn_target "amdgcn-amd-amdhsa--gfx950"
.text
.globl sequential_preLN__mha_block_cached__swiglu_ffn__decode_kernel
.p2align 8
.type sequential_preLN__mha_block_cached__swiglu_ffn__decode_kernel,@function
sequential_preLN__mha_block_cached__swiglu_ffn__decode_kernel:
  s_cmp_ge_u32 s2, 256
  s_cbranch_scc1 K1_END
  s_load_dwordx16 s[36:51], s[0:1], 0
  s_load_dwordx8 s[52:59], s[0:1], 64
  v_and_b32 v1, 63, v0
  v_lshrrev_b32 v104, 6, v0
  v_and_b32 v2, 15, v0
  v_readfirstlane_b32 s34, v104
  v_lshrrev_b32 v3, 4, v1
  v_lshlrev_b32 v4, 4, v1
  s_lshr_b32 s32, s2, 5
  s_and_b32 s33, s2, 31
  s_mov_b32 s35, 0xffff0000
  s_waitcnt lgkmcnt(0)
  s_mov_b32 s4, s36
  s_and_b32 s5, s37, 0xffff
  s_mov_b32 s6, 8192
  s_mov_b32 s7, 0x00020000
  s_lshl_b32 s3, s2, 20
  s_lshr_b32 s60, s2, 12
  s_add_u32 s38, s38, s3
  s_addc_u32 s39, s39, s60
  s_add_u32 s40, s40, s3
  s_addc_u32 s41, s41, s60
  s_mov_b32 s8, s38
  s_and_b32 s9, s39, 0xffff
  s_mov_b32 s10, 1048576
  s_mov_b32 s11, 0x00020000
  s_mov_b32 s12, s40
  s_and_b32 s13, s41, 0xffff
  s_mov_b32 s14, 1048576
  s_mov_b32 s15, 0x00020000
  s_mov_b32 s16, s42
  s_and_b32 s17, s43, 0xffff
  s_mov_b32 s18, 4194304
  s_mov_b32 s19, 0x00020000
  s_mov_b32 s20, s44
  s_and_b32 s21, s45, 0xffff
  s_mov_b32 s22, 4194304
  s_mov_b32 s23, 0x00020000
  s_mov_b32 s24, s58
  s_and_b32 s25, s59, 0xffff
  s_mov_b32 s26, 8388608
  s_mov_b32 s27, 0x00020000
  s_mov_b32 s28, s56
  s_and_b32 s29, s57, 0xffff
  s_mov_b32 s30, 256
  s_mov_b32 s31, 0x00020000
  s_bitcmp1_b32 s2, 1
  s_cselect_b32 s48, s50, s48
  s_cselect_b32 s49, s51, s49
  s_mov_b32 s36, s48
  s_and_b32 s37, s49, 0xffff
  s_mov_b32 s38, 1409024
  s_mov_b32 s39, 0x00020000
  s_mov_b32 s42, 0x100000
  s_mov_b32 s43, 0x00020000
  v_cmp_gt_u32 vcc, 344, v0
  s_and_saveexec_b64 s[66:67], vcc
  s_cbranch_execz K1_RP1
  s_lshr_b32 s3, s2, 2
  s_mul_i32 s3, s3, 22016
  s_and_b32 s62, s2, 1
  s_mul_i32 s62, s62, 1376
  s_add_u32 s3, s3, s62
  v_lshlrev_b32 v120, 2, v0
  buffer_load_dword v64, v120, s[36:39], s3 offen nt
  s_add_u32 s3, s3, 2752
  buffer_load_dword v65, v120, s[36:39], s3 offen nt
  s_add_u32 s3, s3, 2752
  buffer_load_dword v66, v120, s[36:39], s3 offen nt
  s_add_u32 s3, s3, 2752
  buffer_load_dword v67, v120, s[36:39], s3 offen nt
  s_add_u32 s3, s3, 2752
  buffer_load_dword v68, v120, s[36:39], s3 offen nt
  s_add_u32 s3, s3, 2752
  buffer_load_dword v69, v120, s[36:39], s3 offen nt
  s_add_u32 s3, s3, 2752
  buffer_load_dword v70, v120, s[36:39], s3 offen nt
  s_add_u32 s3, s3, 2752
  buffer_load_dword v71, v120, s[36:39], s3 offen nt
K1_RP1:
  s_mov_b64 exec, s[66:67]
  s_lshl_b32 s3, s32, 10
  buffer_load_dwordx4 v[10:13], v4, s[4:7], s3 offen
  s_lshl_b32 s3, s34, 5
  v_add_u32 v105, s3, v3
  v_lshlrev_b32 v105, 13, v105
  v_lshl_add_u32 v105, v2, 4, v105
  s_lshl_b32 s3, s33, 8
  buffer_load_dwordx4 v[16:19], v105, s[16:19], s3 offen nt
  s_add_u32 s3, s3, 32768
  buffer_load_dwordx4 v[20:23], v105, s[16:19], s3 offen nt
  s_add_u32 s3, s3, 32768
  buffer_load_dwordx4 v[24:27], v105, s[16:19], s3 offen nt
  s_add_u32 s3, s3, 32768
  buffer_load_dwordx4 v[28:31], v105, s[16:19], s3 offen nt
  s_add_u32 s3, s3, 32768
  buffer_load_dwordx4 v[32:35], v105, s[16:19], s3 offen nt
  s_add_u32 s3, s3, 32768
  buffer_load_dwordx4 v[36:39], v105, s[16:19], s3 offen nt
  s_add_u32 s3, s3, 32768
  buffer_load_dwordx4 v[40:43], v105, s[16:19], s3 offen nt
  s_add_u32 s3, s3, 32768
  buffer_load_dwordx4 v[44:47], v105, s[16:19], s3 offen nt
  s_barrier
  s_mov_b32 s44, s34
  s_lshl_b32 s61, s34, 12
  s_cmp_lt_u32 s34, 6
  s_cselect_b32 s61, s61, 0x100000
  buffer_load_dwordx4 v[48:51], v4, s[8:11], s61 offen offset:0 nt
  buffer_load_dwordx4 v[52:55], v4, s[8:11], s61 offen offset:1024 nt
  buffer_load_dwordx4 v[56:59], v4, s[8:11], s61 offen offset:2048 nt
  buffer_load_dwordx4 v[60:63], v4, s[8:11], s61 offen offset:3072 nt
  s_waitcnt vmcnt(12)
  v_lshlrev_b32 v104, 16, v10
  v_and_b32 v105, s35, v10
  v_lshlrev_b32 v106, 16, v11
  v_and_b32 v107, s35, v11
  v_lshlrev_b32 v108, 16, v12
  v_and_b32 v109, s35, v12
  v_lshlrev_b32 v110, 16, v13
  v_and_b32 v111, s35, v13
  v_add_f32 v112, v104, v105
  v_add_f32 v113, v106, v107
  v_add_f32 v112, v112, v108
  v_add_f32 v113, v113, v109
  v_add_f32 v112, v112, v110
  v_add_f32 v113, v113, v111
  v_add_f32 v112, v112, v113
  s_nop 1
  v_add_f32_dpp v114, v112, v112 quad_perm:[1,0,3,2] row_mask:0xf bank_mask:0xf
  s_nop 1
  v_add_f32_dpp v115, v114, v114 quad_perm:[2,3,0,1] row_mask:0xf bank_mask:0xf
  s_nop 1
  v_add_f32_dpp v114, v115, v115 row_half_mirror row_mask:0xf bank_mask:0xf
  s_nop 1
  v_add_f32_dpp v115, v114, v114 row_mirror row_mask:0xf bank_mask:0xf
  s_nop 0
  v_readlane_b32 s64, v115, 0
  v_readlane_b32 s65, v115, 16
  v_readlane_b32 s66, v115, 32
  v_readlane_b32 s67, v115, 48
  v_mov_b32 v116, s64
  v_add_f32 v116, s65, v116
  v_add_f32 v116, s66, v116
  v_add_f32 v116, s67, v116
  v_mul_f32 v116, 0x3b000000, v116
  v_mov_b32 v112, 0
  v_mov_b32 v113, 0
  v_sub_f32 v120, v104, v116
  v_sub_f32 v121, v105, v116
  v_fmac_f32 v112, v120, v120
  v_fmac_f32 v113, v121, v121
  v_sub_f32 v120, v106, v116
  v_sub_f32 v121, v107, v116
  v_fmac_f32 v112, v120, v120
  v_fmac_f32 v113, v121, v121
  v_sub_f32 v120, v108, v116
  v_sub_f32 v121, v109, v116
  v_fmac_f32 v112, v120, v120
  v_fmac_f32 v113, v121, v121
  v_sub_f32 v120, v110, v116
  v_sub_f32 v121, v111, v116
  v_fmac_f32 v112, v120, v120
  v_fmac_f32 v113, v121, v121
  v_add_f32 v112, v112, v113
  s_nop 1
  v_add_f32_dpp v114, v112, v112 quad_perm:[1,0,3,2] row_mask:0xf bank_mask:0xf
  s_nop 1
  v_add_f32_dpp v115, v114, v114 quad_perm:[2,3,0,1] row_mask:0xf bank_mask:0xf
  s_nop 1
  v_add_f32_dpp v114, v115, v115 row_half_mirror row_mask:0xf bank_mask:0xf
  s_nop 1
  v_add_f32_dpp v115, v114, v114 row_mirror row_mask:0xf bank_mask:0xf
  s_nop 0
  v_readlane_b32 s64, v115, 0
  v_readlane_b32 s65, v115, 16
  v_readlane_b32 s66, v115, 32
  v_readlane_b32 s67, v115, 48
  v_mov_b32 v118, s64
  v_add_f32 v118, s65, v118
  v_add_f32 v118, s66, v118
  v_add_f32 v118, s67, v118
  v_mul_f32 v118, 0x3b000000, v118
  v_cvt_pk_bf16_f32 v118, v118, v118
  v_and_b32 v118, s35, v118
  v_add_f32 v118, 0x3727c5ac, v118
  v_cvt_pk_bf16_f32 v118, v118, v118
  v_and_b32 v118, s35, v118
  v_sqrt_f32 v118, v118
  s_nop 0
  v_cvt_pk_bf16_f32 v118, v118, v118
  v_and_b32 v118, s35, v118
  v_cvt_pk_bf16_f32 v117, v116, v116
  v_and_b32 v117, s35, v117
  v_rcp_f32 v119, v118
  v_sub_f32 v120, v104, v117
  v_cvt_pk_bf16_f32 v120, v120, v120
  v_and_b32 v120, s35, v120
  v_mul_f32 v121, v120, v119
  v_fma_f32 v122, -v121, v118, v120
  v_fma_f32 v121, v122, v119, v121
  v_cvt_pk_bf16_f32 v104, v121, v121
  v_and_b32 v104, s35, v104
  v_sub_f32 v120, v105, v117
  v_cvt_pk_bf16_f32 v120, v120, v120
  v_and_b32 v120, s35, v120
  v_mul_f32 v121, v120, v119
  v_fma_f32 v122, -v121, v118, v120
  v_fma_f32 v121, v122, v119, v121
  v_cvt_pk_bf16_f32 v105, v121, v121
  v_and_b32 v105, s35, v105
  v_sub_f32 v120, v106, v117
  v_cvt_pk_bf16_f32 v120, v120, v120
  v_and_b32 v120, s35, v120
  v_mul_f32 v121, v120, v119
  v_fma_f32 v122, -v121, v118, v120
  v_fma_f32 v121, v122, v119, v121
  v_cvt_pk_bf16_f32 v106, v121, v121
  v_and_b32 v106, s35, v106
  v_sub_f32 v120, v107, v117
  v_cvt_pk_bf16_f32 v120, v120, v120
  v_and_b32 v120, s35, v120
  v_mul_f32 v121, v120, v119
  v_fma_f32 v122, -v121, v118, v120
  v_fma_f32 v121, v122, v119, v121
  v_cvt_pk_bf16_f32 v107, v121, v121
  v_and_b32 v107, s35, v107
  v_sub_f32 v120, v108, v117
  v_cvt_pk_bf16_f32 v120, v120, v120
  v_and_b32 v120, s35, v120
  v_mul_f32 v121, v120, v119
  v_fma_f32 v122, -v121, v118, v120
  v_fma_f32 v121, v122, v119, v121
  v_cvt_pk_bf16_f32 v108, v121, v121
  v_and_b32 v108, s35, v108
  v_sub_f32 v120, v109, v117
  v_cvt_pk_bf16_f32 v120, v120, v120
  v_and_b32 v120, s35, v120
  v_mul_f32 v121, v120, v119
  v_fma_f32 v122, -v121, v118, v120
  v_fma_f32 v121, v122, v119, v121
  v_cvt_pk_bf16_f32 v109, v121, v121
  v_and_b32 v109, s35, v109
  v_sub_f32 v120, v110, v117
  v_cvt_pk_bf16_f32 v120, v120, v120
  v_and_b32 v120, s35, v120
  v_mul_f32 v121, v120, v119
  v_fma_f32 v122, -v121, v118, v120
  v_fma_f32 v121, v122, v119, v121
  v_cvt_pk_bf16_f32 v110, v121, v121
  v_and_b32 v110, s35, v110
  v_sub_f32 v120, v111, v117
  v_cvt_pk_bf16_f32 v120, v120, v120
  v_and_b32 v120, s35, v120
  v_mul_f32 v121, v120, v119
  v_fma_f32 v122, -v121, v118, v120
  v_fma_f32 v121, v122, v119, v121
  v_cvt_pk_bf16_f32 v111, v121, v121
  v_and_b32 v111, s35, v111
  s_lshl_b32 s3, s34, 11
  v_lshl_add_u32 v112, v1, 5, s3
  ds_write_b128 v112, v[104:107] offset:0
  ds_write_b128 v112, v[108:111] offset:16
  s_lshl_b32 s62, s34, 7
  s_add_u32 s3, s3, s62
  v_lshl_add_u32 v112, v3, 2, s3
  s_waitcnt lgkmcnt(0)
  ds_read_b32 v104, v112 offset:0
  ds_read_b32 v105, v112 offset:16
  ds_read_b32 v106, v112 offset:32
  ds_read_b32 v107, v112 offset:48
  ds_read_b32 v108, v112 offset:64
  ds_read_b32 v109, v112 offset:80
  ds_read_b32 v110, v112 offset:96
  ds_read_b32 v111, v112 offset:112
  v_mov_b32 v113, 6
  v_mov_b32 v114, 0
  ds_write_b32 v114, v113 offset:49412
  s_waitcnt vmcnt(4) lgkmcnt(0)
  v_mov_b32 v96, 0
  v_mov_b32 v97, 0
  v_mov_b32 v98, 0
  v_mov_b32 v99, 0
  v_mov_b32 v100, 0
  v_mov_b32 v101, 0
  v_mov_b32 v102, 0
  v_mov_b32 v103, 0
  v_lshrrev_b32 v112, 16, v104
  v_dot2_f32_bf16 v96, v16, v112, v96
  v_dot2_f32_bf16 v97, v16, v104, v97
  v_dot2_f32_bf16 v98, v17, v112, v98
  v_dot2_f32_bf16 v99, v17, v104, v99
  v_dot2_f32_bf16 v100, v18, v112, v100
  v_dot2_f32_bf16 v101, v18, v104, v101
  v_dot2_f32_bf16 v102, v19, v112, v102
  v_dot2_f32_bf16 v103, v19, v104, v103
  v_lshrrev_b32 v113, 16, v105
  v_dot2_f32_bf16 v96, v20, v113, v96
  v_dot2_f32_bf16 v97, v20, v105, v97
  v_dot2_f32_bf16 v98, v21, v113, v98
  v_dot2_f32_bf16 v99, v21, v105, v99
  v_dot2_f32_bf16 v100, v22, v113, v100
  v_dot2_f32_bf16 v101, v22, v105, v101
  v_dot2_f32_bf16 v102, v23, v113, v102
  v_dot2_f32_bf16 v103, v23, v105, v103
  v_lshrrev_b32 v112, 16, v106
  v_dot2_f32_bf16 v96, v24, v112, v96
  v_dot2_f32_bf16 v97, v24, v106, v97
  v_dot2_f32_bf16 v98, v25, v112, v98
  v_dot2_f32_bf16 v99, v25, v106, v99
  v_dot2_f32_bf16 v100, v26, v112, v100
  v_dot2_f32_bf16 v101, v26, v106, v101
  v_dot2_f32_bf16 v102, v27, v112, v102
  v_dot2_f32_bf16 v103, v27, v106, v103
  v_lshrrev_b32 v113, 16, v107
  v_dot2_f32_bf16 v96, v28, v113, v96
  v_dot2_f32_bf16 v97, v28, v107, v97
  v_dot2_f32_bf16 v98, v29, v113, v98
  v_dot2_f32_bf16 v99, v29, v107, v99
  v_dot2_f32_bf16 v100, v30, v113, v100
  v_dot2_f32_bf16 v101, v30, v107, v101
  v_dot2_f32_bf16 v102, v31, v113, v102
  v_dot2_f32_bf16 v103, v31, v107, v103
  v_lshrrev_b32 v112, 16, v108
  v_dot2_f32_bf16 v96, v32, v112, v96
  v_dot2_f32_bf16 v97, v32, v108, v97
  v_dot2_f32_bf16 v98, v33, v112, v98
  v_dot2_f32_bf16 v99, v33, v108, v99
  v_dot2_f32_bf16 v100, v34, v112, v100
  v_dot2_f32_bf16 v101, v34, v108, v101
  v_dot2_f32_bf16 v102, v35, v112, v102
  v_dot2_f32_bf16 v103, v35, v108, v103
  v_lshrrev_b32 v113, 16, v109
  v_dot2_f32_bf16 v96, v36, v113, v96
  v_dot2_f32_bf16 v97, v36, v109, v97
  v_dot2_f32_bf16 v98, v37, v113, v98
  v_dot2_f32_bf16 v99, v37, v109, v99
  v_dot2_f32_bf16 v100, v38, v113, v100
  v_dot2_f32_bf16 v101, v38, v109, v101
  v_dot2_f32_bf16 v102, v39, v113, v102
  v_dot2_f32_bf16 v103, v39, v109, v103
  v_lshrrev_b32 v112, 16, v110
  v_dot2_f32_bf16 v96, v40, v112, v96
  v_dot2_f32_bf16 v97, v40, v110, v97
  v_dot2_f32_bf16 v98, v41, v112, v98
  v_dot2_f32_bf16 v99, v41, v110, v99
  v_dot2_f32_bf16 v100, v42, v112, v100
  v_dot2_f32_bf16 v101, v42, v110, v101
  v_dot2_f32_bf16 v102, v43, v112, v102
  v_dot2_f32_bf16 v103, v43, v110, v103
  v_lshrrev_b32 v113, 16, v111
  v_dot2_f32_bf16 v96, v44, v113, v96
  v_dot2_f32_bf16 v97, v44, v111, v97
  v_dot2_f32_bf16 v98, v45, v113, v98
  v_dot2_f32_bf16 v99, v45, v111, v99
  v_dot2_f32_bf16 v100, v46, v113, v100
  v_dot2_f32_bf16 v101, v46, v111, v101
  v_dot2_f32_bf16 v102, v47, v113, v102
  v_dot2_f32_bf16 v103, v47, v111, v103
  v_cmp_gt_u32 vcc, 344, v0
  s_and_saveexec_b64 s[66:67], vcc
  s_cbranch_execz K1_RP2
  s_mov_b32 s3, 0x05040100
  s_mov_b32 s62, 0x07060302
  v_perm_b32 v72, v65, v64, s3
  v_perm_b32 v76, v65, v64, s62
  v_perm_b32 v73, v67, v66, s3
  v_perm_b32 v77, v67, v66, s62
  v_perm_b32 v74, v69, v68, s3
  v_perm_b32 v78, v69, v68, s62
  v_perm_b32 v75, v71, v70, s3
  v_perm_b32 v79, v71, v70, s62
  s_and_b32 s3, s2, 1
  s_mul_i32 s3, s3, 344
  v_add_u32 v120, s3, v0
  v_lshrrev_b32 v121, 3, v120
  v_lshlrev_b32 v121, 15, v121
  v_and_b32 v120, 7, v120
  v_lshl_add_u32 v120, v120, 5, v121
  s_lshr_b32 s3, s2, 2
  s_lshl_b32 s3, s3, 8
  s_bfe_u32 s62, s2, 0x10001
  s_lshl_b32 s62, s62, 14
  s_add_u32 s3, s3, s62
  s_add_u32 s3, s3, 2621440
  buffer_store_dwordx4 v[72:75], v120, s[24:27], s3 offen sc1
  buffer_store_dwordx4 v[76:79], v120, s[24:27], s3 offen offset:16 sc1
K1_RP2:
  s_mov_b64 exec, s[66:67]
  s_cmp_lt_u32 s34, 6
  s_cbranch_scc1 K1_HVa
  s_waitcnt vmcnt(0)
  s_sub_u32 s61, s34, 6
  s_mul_i32 s61, s61, 3
  s_add_u32 s61, s61, 226
  s_add_u32 s44, s61, 256
  s_add_u32 s62, s61, 0
  s_lshl_b32 s62, s62, 12
  buffer_load_dwordx4 v[48:51], v4, s[12:15], s62 offen offset:0 nt
  buffer_load_dwordx4 v[52:55], v4, s[12:15], s62 offen offset:1024 nt
  buffer_load_dwordx4 v[56:59], v4, s[12:15], s62 offen offset:2048 nt
  buffer_load_dwordx4 v[60:63], v4, s[12:15], s62 offen offset:3072 nt
  s_add_u32 s45, s61, 257
  s_add_u32 s62, s61, 1
  s_lshl_b32 s62, s62, 12
  buffer_load_dwordx4 v[64:67], v4, s[12:15], s62 offen offset:0 nt
  buffer_load_dwordx4 v[68:71], v4, s[12:15], s62 offen offset:1024 nt
  buffer_load_dwordx4 v[72:75], v4, s[12:15], s62 offen offset:2048 nt
  buffer_load_dwordx4 v[76:79], v4, s[12:15], s62 offen offset:3072 nt
  s_add_u32 s46, s61, 258
  s_add_u32 s62, s61, 2
  s_lshl_b32 s62, s62, 12
  buffer_load_dwordx4 v[80:83], v4, s[12:15], s62 offen offset:0 nt
  buffer_load_dwordx4 v[84:87], v4, s[12:15], s62 offen offset:1024 nt
  buffer_load_dwordx4 v[88:91], v4, s[12:15], s62 offen offset:2048 nt
  buffer_load_dwordx4 v[92:95], v4, s[12:15], s62 offen offset:3072 nt
K1_HVa:
  s_nop 4
  v_permlane32_swap_b32 v96, v97
  v_permlane32_swap_b32 v98, v99
  v_permlane32_swap_b32 v100, v101
  v_permlane32_swap_b32 v102, v103
  v_add_f32 v96, v96, v97
  v_add_f32 v98, v98, v99
  v_add_f32 v100, v100, v101
  v_add_f32 v102, v102, v103
  v_permlane16_swap_b32 v96, v98
  s_nop 0
  v_permlane16_swap_b32 v100, v102
  v_add_f32 v96, v96, v98
  v_add_f32 v100, v100, v102
  v_and_b32 v104, 1, v3
  v_lshlrev_b32 v104, 3, v104
  v_lshrrev_b32 v105, 1, v3
  v_lshl_add_u32 v104, v105, 2, v104
  v_lshl_add_u32 v104, v2, 5, v104
  s_lshl_b32 s3, s34, 9
  v_add_u32 v14, s3, v104
  v_lshrrev_b32 v15, 2, v1
  v_lshlrev_b32 v15, 2, v15
  ds_write_b32 v14, v96 offset:32768
  ds_write_b32 v14, v100 offset:32784
  s_waitcnt lgkmcnt(0)
  s_barrier
  v_mov_b32 v9, 0xff800000
  s_cmp_lt_u32 s34, 6
  s_cbranch_scc1 K1_STREAM0
  s_lshl_b32 s3, s33, 7
  s_lshl_b32 s62, s34, 3
  s_add_u32 s3, s3, s62
  s_lshl_b32 s3, s3, 10
  buffer_load_dwordx4 v[16:19], v4, s[20:23], s3 offen offset:0 nt
  buffer_load_dwordx4 v[20:23], v4, s[20:23], s3 offen offset:1024 nt
  buffer_load_dwordx4 v[24:27], v4, s[20:23], s3 offen offset:2048 nt
  buffer_load_dwordx4 v[28:31], v4, s[20:23], s3 offen offset:3072 nt
  s_add_u32 s3, s3, 4096
  buffer_load_dwordx4 v[32:35], v4, s[20:23], s3 offen offset:0 nt
  buffer_load_dwordx4 v[36:39], v4, s[20:23], s3 offen offset:1024 nt
  buffer_load_dwordx4 v[40:43], v4, s[20:23], s3 offen offset:2048 nt
  buffer_load_dwordx4 v[44:47], v4, s[20:23], s3 offen offset:3072 nt
  s_branch K1_SOFTMAX
K1_STREAM0:
  v_lshlrev_b32 v120, 3, v1
  ds_read_b64 v[104:105], v120 offset:32768
  ds_read_b64 v[106:107], v120 offset:33280
  ds_read_b64 v[108:109], v120 offset:33792
  ds_read_b64 v[110:111], v120 offset:34304
  ds_read_b64 v[112:113], v120 offset:34816
  ds_read_b64 v[114:115], v120 offset:35328
  ds_read_b64 v[116:117], v120 offset:35840
  ds_read_b64 v[118:119], v120 offset:36352
  s_waitcnt lgkmcnt(0)
  v_add_f32 v104, v104, v106
  v_add_f32 v108, v108, v110
  v_add_f32 v112, v112, v114
  v_add_f32 v116, v116, v118
  v_add_f32 v104, v104, v108
  v_add_f32 v112, v112, v116
  v_add_f32 v96, v104, v112
  v_add_f32 v105, v105, v107
  v_add_f32 v109, v109, v111
  v_add_f32 v113, v113, v115
  v_add_f32 v117, v117, v119
  v_add_f32 v105, v105, v109
  v_add_f32 v113, v113, v117
  v_add_f32 v97, v105, v113
  ds_read_b64 v[104:105], v120 offset:36864
  ds_read_b64 v[106:107], v120 offset:37376
  ds_read_b64 v[108:109], v120 offset:37888
  ds_read_b64 v[110:111], v120 offset:38400
  ds_read_b64 v[112:113], v120 offset:38912
  ds_read_b64 v[114:115], v120 offset:39424
  ds_read_b64 v[116:117], v120 offset:39936
  ds_read_b64 v[118:119], v120 offset:40448
  s_waitcnt lgkmcnt(0)
  v_add_f32 v104, v104, v106
  v_add_f32 v108, v108, v110
  v_add_f32 v112, v112, v114
  v_add_f32 v116, v116, v118
  v_add_f32 v104, v104, v108
  v_add_f32 v112, v112, v116
  v_add_f32 v104, v104, v112
  v_add_f32 v96, v96, v104
  v_add_f32 v105, v105, v107
  v_add_f32 v109, v109, v111
  v_add_f32 v113, v113, v115
  v_add_f32 v117, v117, v119
  v_add_f32 v105, v105, v109
  v_add_f32 v113, v113, v117
  v_add_f32 v105, v105, v113
  v_add_f32 v97, v97, v105
  v_cvt_pk_bf16_f32 v96, v96, v97
  v_lshlrev_b32 v104, 4, v2
  v_add_u32 v105, 0, v104
  v_add_u32 v106, 4, v104
  v_add_u32 v107, 8, v104
  v_add_u32 v108, 12, v104
  ds_bpermute_b32 v5, v105, v96
  ds_bpermute_b32 v6, v106, v96
  ds_bpermute_b32 v7, v107, v96
  ds_bpermute_b32 v8, v108, v96
  s_waitcnt lgkmcnt(0)
  s_mov_b32 s63, 0x3db504f3
  v_mov_b32 v124, 1
  v_mov_b32 v125, 49412
K1_KL:
  s_cmp_ge_u32 s44, 256
  s_cbranch_scc1 K1_KT
  s_mov_b64 exec, 1
  ds_add_rtn_u32 v126, v125, v124
  s_mov_b64 exec, -1
  s_waitcnt vmcnt(0)
  v_dot2_f32_bf16 v104, v48, v5, 0
  v_dot2_f32_bf16 v105, v52, v5, 0
  v_dot2_f32_bf16 v106, v56, v5, 0
  v_dot2_f32_bf16 v107, v60, v5, 0
  v_dot2_f32_bf16 v104, v49, v6, v104
  v_dot2_f32_bf16 v105, v53, v6, v105
  v_dot2_f32_bf16 v106, v57, v6, v106
  v_dot2_f32_bf16 v107, v61, v6, v107
  v_dot2_f32_bf16 v104, v50, v7, v104
  v_dot2_f32_bf16 v105, v54, v7, v105
  v_dot2_f32_bf16 v106, v58, v7, v106
  v_dot2_f32_bf16 v107, v62, v7, v107
  v_dot2_f32_bf16 v104, v51, v8, v104
  v_dot2_f32_bf16 v105, v55, v8, v105
  v_dot2_f32_bf16 v106, v59, v8, v106
  v_dot2_f32_bf16 v107, v63, v8, v107
  s_waitcnt lgkmcnt(0)
  v_readfirstlane_b32 s74, v126
  s_cmp_lt_u32 s74, 256
  s_cselect_b32 s40, s8, s12
  s_cselect_b32 s41, s9, s13
  s_and_b32 s61, s74, 255
  s_lshl_b32 s61, s61, 12
  s_cmp_lt_u32 s74, 482
  s_cselect_b32 s61, s61, 0x100000
  buffer_load_dwordx4 v[48:51], v4, s[40:43], s61 offen offset:0 nt
  buffer_load_dwordx4 v[52:55], v4, s[40:43], s61 offen offset:1024 nt
  buffer_load_dwordx4 v[56:59], v4, s[40:43], s61 offen offset:2048 nt
  buffer_load_dwordx4 v[60:63], v4, s[40:43], s61 offen offset:3072 nt
  v_add_f32_dpp v108, v104, v104 row_ror:8 row_mask:0xf bank_mask:0x3
  v_add_f32_dpp v109, v106, v106 row_ror:8 row_mask:0xf bank_mask:0x3
  v_add_f32_dpp v108, v105, v105 row_ror:8 row_mask:0xf bank_mask:0xc
  v_add_f32_dpp v109, v107, v107 row_ror:8 row_mask:0xf bank_mask:0xc
  s_nop 0
  v_add_f32_dpp v110, v108, v108 row_half_mirror row_mask:0xf bank_mask:0x5
  v_add_f32_dpp v110, v109, v109 row_half_mirror row_mask:0xf bank_mask:0xa
  s_nop 1
  v_add_f32_dpp v111, v110, v110 quad_perm:[1,0,3,2] row_mask:0xf bank_mask:0xf
  s_nop 1
  v_add_f32_dpp v110, v111, v111 quad_perm:[2,3,0,1] row_mask:0xf bank_mask:0xf
  s_lshl_b32 s3, s44, 6
  v_add_u32 v111, s3, v15
  v_cvt_pk_bf16_f32 v110, v110, v110
  v_and_b32 v110, s35, v110
  v_mul_f32 v110, s63, v110
  v_cvt_pk_bf16_f32 v110, v110, v110
  v_and_b32 v110, s35, v110
  ds_write_b32 v111, v110 offset:0
  v_max_f32 v9, v9, v110
  s_mov_b32 s44, s74
  s_branch K1_KL
K1_KT:
  s_mov_b64 exec, 1
  ds_add_rtn_u32 v126, v125, v124
  s_mov_b64 exec, -1
  s_waitcnt lgkmcnt(0)
  v_readfirstlane_b32 s74, v126
  s_cmp_lt_u32 s74, 256
  s_cselect_b32 s40, s8, s12
  s_cselect_b32 s41, s9, s13
  s_and_b32 s61, s74, 255
  s_lshl_b32 s61, s61, 12
  s_cmp_lt_u32 s74, 482
  s_cselect_b32 s61, s61, 0x100000
  buffer_load_dwordx4 v[64:67], v4, s[40:43], s61 offen offset:0 nt
  buffer_load_dwordx4 v[68:71], v4, s[40:43], s61 offen offset:1024 nt
  buffer_load_dwordx4 v[72:75], v4, s[40:43], s61 offen offset:2048 nt
  buffer_load_dwordx4 v[76:79], v4, s[40:43], s61 offen offset:3072 nt
  s_mov_b32 s45, s74
  s_mov_b64 exec, 1
  ds_add_rtn_u32 v126, v125, v124
  s_mov_b64 exec, -1
  s_waitcnt lgkmcnt(0)
  v_readfirstlane_b32 s74, v126
  s_cmp_lt_u32 s74, 256
  s_cselect_b32 s40, s8, s12
  s_cselect_b32 s41, s9, s13
  s_and_b32 s61, s74, 255
  s_lshl_b32 s61, s61, 12
  s_cmp_lt_u32 s74, 482
  s_cselect_b32 s61, s61, 0x100000
  buffer_load_dwordx4 v[80:83], v4, s[40:43], s61 offen offset:0 nt
  buffer_load_dwordx4 v[84:87], v4, s[40:43], s61 offen offset:1024 nt
  buffer_load_dwordx4 v[88:91], v4, s[40:43], s61 offen offset:2048 nt
  buffer_load_dwordx4 v[92:95], v4, s[40:43], s61 offen offset:3072 nt
  s_mov_b32 s46, s74
  s_lshl_b32 s3, s33, 7
  s_lshl_b32 s62, s34, 3
  s_add_u32 s3, s3, s62
  s_lshl_b32 s3, s3, 10
  buffer_load_dwordx4 v[16:19], v4, s[20:23], s3 offen offset:0 nt
  buffer_load_dwordx4 v[20:23], v4, s[20:23], s3 offen offset:1024 nt
  buffer_load_dwordx4 v[24:27], v4, s[20:23], s3 offen offset:2048 nt
  buffer_load_dwordx4 v[28:31], v4, s[20:23], s3 offen offset:3072 nt
  s_add_u32 s3, s3, 4096
  buffer_load_dwordx4 v[32:35], v4, s[20:23], s3 offen offset:0 nt
  buffer_load_dwordx4 v[36:39], v4, s[20:23], s3 offen offset:1024 nt
  buffer_load_dwordx4 v[40:43], v4, s[20:23], s3 offen offset:2048 nt
  buffer_load_dwordx4 v[44:47], v4, s[20:23], s3 offen offset:3072 nt
K1_SOFTMAX:
  v_max_f32_dpp v104, v9, v9 quad_perm:[1,0,3,2] row_mask:0xf bank_mask:0xf
  s_nop 1
  v_max_f32_dpp v105, v104, v104 quad_perm:[2,3,0,1] row_mask:0xf bank_mask:0xf
  s_nop 1
  v_max_f32_dpp v104, v105, v105 row_half_mirror row_mask:0xf bank_mask:0xf
  s_nop 1
  v_max_f32_dpp v105, v104, v104 row_mirror row_mask:0xf bank_mask:0xf
  s_nop 0
  v_readlane_b32 s64, v105, 0
  v_readlane_b32 s65, v105, 16
  v_readlane_b32 s66, v105, 32
  v_readlane_b32 s67, v105, 48
  v_mov_b32 v106, s64
  v_max_f32 v106, s65, v106
  v_max_f32 v106, s66, v106
  v_max_f32 v106, s67, v106
  s_lshl_b32 s3, s34, 2
  v_mov_b32 v104, s3
  ds_write_b32 v104, v106 offset:40960
  s_waitcnt lgkmcnt(0)
  s_barrier
  s_cmp_lg_u32 s34, 0
  s_cbranch_scc1 K1_NOCP
  s_mov_b64 exec, 1
  v_mov_b32 v116, 1
  v_mov_b32 v117, 192
  buffer_atomic_add v116, v117, s[28:31], 0 offen
  s_mov_b64 exec, -1
K1_NOCP:
  v_lshlrev_b32 v115, 2, v2
  v_lshlrev_b32 v107, 4, v0
  ds_read_b32 v106, v115 offset:40960
  ds_read_b128 v[108:111], v107 offset:0
  s_mov_b32 s63, 0x3fb8aa3b
  s_waitcnt lgkmcnt(1)
  v_max_f32_dpp v104, v106, v106 quad_perm:[1,0,3,2] row_mask:0xf bank_mask:0xf
  s_nop 1
  v_max_f32_dpp v112, v104, v104 quad_perm:[2,3,0,1] row_mask:0xf bank_mask:0xf
  s_nop 1
  v_max_f32_dpp v104, v112, v112 row_half_mirror row_mask:0xf bank_mask:0xf
  s_nop 1
  v_max_f32_dpp v112, v104, v104 row_mirror row_mask:0xf bank_mask:0xf
  s_waitcnt lgkmcnt(0)
  v_sub_f32 v108, v108, v112
  v_sub_f32 v109, v109, v112
  v_sub_f32 v110, v110, v112
  v_sub_f32 v111, v111, v112
  v_mul_f32 v108, s63, v108
  v_mul_f32 v109, s63, v109
  v_mul_f32 v110, s63, v110
  v_mul_f32 v111, s63, v111
  v_exp_f32 v108, v108
  v_exp_f32 v109, v109
  v_exp_f32 v110, v110
  v_exp_f32 v111, v111
  v_add_f32 v108, v108, v109
  v_add_f32 v110, v110, v111
  v_add_f32 v108, v108, v110
  s_nop 1
  v_add_f32_dpp v104, v108, v108 quad_perm:[1,0,3,2] row_mask:0xf bank_mask:0xf
  s_nop 1
  v_add_f32_dpp v105, v104, v104 quad_perm:[2,3,0,1] row_mask:0xf bank_mask:0xf
  s_nop 1
  v_add_f32_dpp v104, v105, v105 row_half_mirror row_mask:0xf bank_mask:0xf
  s_nop 1
  v_add_f32_dpp v105, v104, v104 row_mirror row_mask:0xf bank_mask:0xf
  s_nop 0
  v_readlane_b32 s64, v105, 0
  v_readlane_b32 s65, v105, 16
  v_readlane_b32 s66, v105, 32
  v_readlane_b32 s67, v105, 48
  v_mov_b32 v106, s64
  v_add_f32 v106, s65, v106
  v_add_f32 v106, s66, v106
  v_add_f32 v106, s67, v106
  v_mov_b32 v104, s3
  ds_write_b32 v104, v106 offset:41024
  s_waitcnt lgkmcnt(0)
  s_barrier
  ds_read_b32 v106, v115 offset:41024
  s_waitcnt lgkmcnt(0)
  v_add_f32_dpp v104, v106, v106 quad_perm:[1,0,3,2] row_mask:0xf bank_mask:0xf
  s_nop 1
  v_add_f32_dpp v113, v104, v104 quad_perm:[2,3,0,1] row_mask:0xf bank_mask:0xf
  s_nop 1
  v_add_f32_dpp v104, v113, v113 row_half_mirror row_mask:0xf bank_mask:0xf
  s_nop 1
  v_add_f32_dpp v113, v104, v104 row_mirror row_mask:0xf bank_mask:0xf
  v_rcp_f32 v114, v113
  v_mov_b32 v96, 0
  v_mov_b32 v97, 0
  v_mov_b32 v98, 0
  v_mov_b32 v99, 0
  v_mov_b32 v100, 0
  v_mov_b32 v101, 0
  v_mov_b32 v102, 0
  v_mov_b32 v103, 0
  s_cmp_lt_u32 s34, 6
  s_cbranch_scc1 K1_VS
  s_lshl_b32 s3, s44, 6
  s_sub_u32 s3, s3, 16384
  v_add_u32 v105, s3, v15
  ds_read_b32 v104, v105 offset:0
  s_waitcnt lgkmcnt(0)
  v_sub_f32 v104, v104, v112
  v_mul_f32 v104, s63, v104
  v_exp_f32 v104, v104
  s_nop 0
  v_mul_f32 v105, v104, v114
  v_fma_f32 v106, -v105, v113, v104
  v_fma_f32 v105, v106, v114, v105
  v_cvt_pk_bf16_f32 v109, v105, v105
  v_and_b32 v109, s35, v109
  v_lshrrev_b32 v110, 16, v109
  s_waitcnt vmcnt(16)
  s_nop 0
  v_dot2c_f32_bf16_dpp v96, v110, v48 row_newbcast:0 row_mask:0xf bank_mask:0xf
  v_dot2c_f32_bf16_dpp v97, v109, v48 row_newbcast:0 row_mask:0xf bank_mask:0xf
  v_dot2c_f32_bf16_dpp v98, v110, v49 row_newbcast:0 row_mask:0xf bank_mask:0xf
  v_dot2c_f32_bf16_dpp v99, v109, v49 row_newbcast:0 row_mask:0xf bank_mask:0xf
  v_dot2c_f32_bf16_dpp v100, v110, v50 row_newbcast:0 row_mask:0xf bank_mask:0xf
  v_dot2c_f32_bf16_dpp v101, v109, v50 row_newbcast:0 row_mask:0xf bank_mask:0xf
  v_dot2c_f32_bf16_dpp v102, v110, v51 row_newbcast:0 row_mask:0xf bank_mask:0xf
  v_dot2c_f32_bf16_dpp v103, v109, v51 row_newbcast:0 row_mask:0xf bank_mask:0xf
  v_dot2c_f32_bf16_dpp v96, v110, v52 row_newbcast:8 row_mask:0xf bank_mask:0xf
  v_dot2c_f32_bf16_dpp v97, v109, v52 row_newbcast:8 row_mask:0xf bank_mask:0xf
  v_dot2c_f32_bf16_dpp v98, v110, v53 row_newbcast:8 row_mask:0xf bank_mask:0xf
  v_dot2c_f32_bf16_dpp v99, v109, v53 row_newbcast:8 row_mask:0xf bank_mask:0xf
  v_dot2c_f32_bf16_dpp v100, v110, v54 row_newbcast:8 row_mask:0xf bank_mask:0xf
  v_dot2c_f32_bf16_dpp v101, v109, v54 row_newbcast:8 row_mask:0xf bank_mask:0xf
  v_dot2c_f32_bf16_dpp v102, v110, v55 row_newbcast:8 row_mask:0xf bank_mask:0xf
  v_dot2c_f32_bf16_dpp v103, v109, v55 row_newbcast:8 row_mask:0xf bank_mask:0xf
  v_dot2c_f32_bf16_dpp v96, v110, v56 row_newbcast:4 row_mask:0xf bank_mask:0xf
  v_dot2c_f32_bf16_dpp v97, v109, v56 row_newbcast:4 row_mask:0xf bank_mask:0xf
  v_dot2c_f32_bf16_dpp v98, v110, v57 row_newbcast:4 row_mask:0xf bank_mask:0xf
  v_dot2c_f32_bf16_dpp v99, v109, v57 row_newbcast:4 row_mask:0xf bank_mask:0xf
  v_dot2c_f32_bf16_dpp v100, v110, v58 row_newbcast:4 row_mask:0xf bank_mask:0xf
  v_dot2c_f32_bf16_dpp v101, v109, v58 row_newbcast:4 row_mask:0xf bank_mask:0xf
  v_dot2c_f32_bf16_dpp v102, v110, v59 row_newbcast:4 row_mask:0xf bank_mask:0xf
  v_dot2c_f32_bf16_dpp v103, v109, v59 row_newbcast:4 row_mask:0xf bank_mask:0xf
  v_dot2c_f32_bf16_dpp v96, v110, v60 row_newbcast:12 row_mask:0xf bank_mask:0xf
  v_dot2c_f32_bf16_dpp v97, v109, v60 row_newbcast:12 row_mask:0xf bank_mask:0xf
  v_dot2c_f32_bf16_dpp v98, v110, v61 row_newbcast:12 row_mask:0xf bank_mask:0xf
  v_dot2c_f32_bf16_dpp v99, v109, v61 row_newbcast:12 row_mask:0xf bank_mask:0xf
  v_dot2c_f32_bf16_dpp v100, v110, v62 row_newbcast:12 row_mask:0xf bank_mask:0xf
  v_dot2c_f32_bf16_dpp v101, v109, v62 row_newbcast:12 row_mask:0xf bank_mask:0xf
  v_dot2c_f32_bf16_dpp v102, v110, v63 row_newbcast:12 row_mask:0xf bank_mask:0xf
  v_dot2c_f32_bf16_dpp v103, v109, v63 row_newbcast:12 row_mask:0xf bank_mask:0xf
  s_lshl_b32 s3, s45, 6
  s_sub_u32 s3, s3, 16384
  v_add_u32 v105, s3, v15
  ds_read_b32 v104, v105 offset:0
  s_waitcnt lgkmcnt(0)
  v_sub_f32 v104, v104, v112
  v_mul_f32 v104, s63, v104
  v_exp_f32 v104, v104
  s_nop 0
  v_mul_f32 v105, v104, v114
  v_fma_f32 v106, -v105, v113, v104
  v_fma_f32 v105, v106, v114, v105
  v_cvt_pk_bf16_f32 v109, v105, v105
  v_and_b32 v109, s35, v109
  v_lshrrev_b32 v110, 16, v109
  s_waitcnt vmcnt(12)
  s_nop 0
  v_dot2c_f32_bf16_dpp v96, v110, v64 row_newbcast:0 row_mask:0xf bank_mask:0xf
  v_dot2c_f32_bf16_dpp v97, v109, v64 row_newbcast:0 row_mask:0xf bank_mask:0xf
  v_dot2c_f32_bf16_dpp v98, v110, v65 row_newbcast:0 row_mask:0xf bank_mask:0xf
  v_dot2c_f32_bf16_dpp v99, v109, v65 row_newbcast:0 row_mask:0xf bank_mask:0xf
  v_dot2c_f32_bf16_dpp v100, v110, v66 row_newbcast:0 row_mask:0xf bank_mask:0xf
  v_dot2c_f32_bf16_dpp v101, v109, v66 row_newbcast:0 row_mask:0xf bank_mask:0xf
  v_dot2c_f32_bf16_dpp v102, v110, v67 row_newbcast:0 row_mask:0xf bank_mask:0xf
  v_dot2c_f32_bf16_dpp v103, v109, v67 row_newbcast:0 row_mask:0xf bank_mask:0xf
  v_dot2c_f32_bf16_dpp v96, v110, v68 row_newbcast:8 row_mask:0xf bank_mask:0xf
  v_dot2c_f32_bf16_dpp v97, v109, v68 row_newbcast:8 row_mask:0xf bank_mask:0xf
  v_dot2c_f32_bf16_dpp v98, v110, v69 row_newbcast:8 row_mask:0xf bank_mask:0xf
  v_dot2c_f32_bf16_dpp v99, v109, v69 row_newbcast:8 row_mask:0xf bank_mask:0xf
  v_dot2c_f32_bf16_dpp v100, v110, v70 row_newbcast:8 row_mask:0xf bank_mask:0xf
  v_dot2c_f32_bf16_dpp v101, v109, v70 row_newbcast:8 row_mask:0xf bank_mask:0xf
  v_dot2c_f32_bf16_dpp v102, v110, v71 row_newbcast:8 row_mask:0xf bank_mask:0xf
  v_dot2c_f32_bf16_dpp v103, v109, v71 row_newbcast:8 row_mask:0xf bank_mask:0xf
  v_dot2c_f32_bf16_dpp v96, v110, v72 row_newbcast:4 row_mask:0xf bank_mask:0xf
  v_dot2c_f32_bf16_dpp v97, v109, v72 row_newbcast:4 row_mask:0xf bank_mask:0xf
  v_dot2c_f32_bf16_dpp v98, v110, v73 row_newbcast:4 row_mask:0xf bank_mask:0xf
  v_dot2c_f32_bf16_dpp v99, v109, v73 row_newbcast:4 row_mask:0xf bank_mask:0xf
  v_dot2c_f32_bf16_dpp v100, v110, v74 row_newbcast:4 row_mask:0xf bank_mask:0xf
  v_dot2c_f32_bf16_dpp v101, v109, v74 row_newbcast:4 row_mask:0xf bank_mask:0xf
  v_dot2c_f32_bf16_dpp v102, v110, v75 row_newbcast:4 row_mask:0xf bank_mask:0xf
  v_dot2c_f32_bf16_dpp v103, v109, v75 row_newbcast:4 row_mask:0xf bank_mask:0xf
  v_dot2c_f32_bf16_dpp v96, v110, v76 row_newbcast:12 row_mask:0xf bank_mask:0xf
  v_dot2c_f32_bf16_dpp v97, v109, v76 row_newbcast:12 row_mask:0xf bank_mask:0xf
  v_dot2c_f32_bf16_dpp v98, v110, v77 row_newbcast:12 row_mask:0xf bank_mask:0xf
  v_dot2c_f32_bf16_dpp v99, v109, v77 row_newbcast:12 row_mask:0xf bank_mask:0xf
  v_dot2c_f32_bf16_dpp v100, v110, v78 row_newbcast:12 row_mask:0xf bank_mask:0xf
  v_dot2c_f32_bf16_dpp v101, v109, v78 row_newbcast:12 row_mask:0xf bank_mask:0xf
  v_dot2c_f32_bf16_dpp v102, v110, v79 row_newbcast:12 row_mask:0xf bank_mask:0xf
  v_dot2c_f32_bf16_dpp v103, v109, v79 row_newbcast:12 row_mask:0xf bank_mask:0xf
  s_lshl_b32 s3, s46, 6
  s_sub_u32 s3, s3, 16384
  v_add_u32 v105, s3, v15
  ds_read_b32 v104, v105 offset:0
  s_waitcnt lgkmcnt(0)
  v_sub_f32 v104, v104, v112
  v_mul_f32 v104, s63, v104
  v_exp_f32 v104, v104
  s_nop 0
  v_mul_f32 v105, v104, v114
  v_fma_f32 v106, -v105, v113, v104
  v_fma_f32 v105, v106, v114, v105
  v_cvt_pk_bf16_f32 v109, v105, v105
  v_and_b32 v109, s35, v109
  v_lshrrev_b32 v110, 16, v109
  s_waitcnt vmcnt(8)
  s_nop 0
  v_dot2c_f32_bf16_dpp v96, v110, v80 row_newbcast:0 row_mask:0xf bank_mask:0xf
  v_dot2c_f32_bf16_dpp v97, v109, v80 row_newbcast:0 row_mask:0xf bank_mask:0xf
  v_dot2c_f32_bf16_dpp v98, v110, v81 row_newbcast:0 row_mask:0xf bank_mask:0xf
  v_dot2c_f32_bf16_dpp v99, v109, v81 row_newbcast:0 row_mask:0xf bank_mask:0xf
  v_dot2c_f32_bf16_dpp v100, v110, v82 row_newbcast:0 row_mask:0xf bank_mask:0xf
  v_dot2c_f32_bf16_dpp v101, v109, v82 row_newbcast:0 row_mask:0xf bank_mask:0xf
  v_dot2c_f32_bf16_dpp v102, v110, v83 row_newbcast:0 row_mask:0xf bank_mask:0xf
  v_dot2c_f32_bf16_dpp v103, v109, v83 row_newbcast:0 row_mask:0xf bank_mask:0xf
  v_dot2c_f32_bf16_dpp v96, v110, v84 row_newbcast:8 row_mask:0xf bank_mask:0xf
  v_dot2c_f32_bf16_dpp v97, v109, v84 row_newbcast:8 row_mask:0xf bank_mask:0xf
  v_dot2c_f32_bf16_dpp v98, v110, v85 row_newbcast:8 row_mask:0xf bank_mask:0xf
  v_dot2c_f32_bf16_dpp v99, v109, v85 row_newbcast:8 row_mask:0xf bank_mask:0xf
  v_dot2c_f32_bf16_dpp v100, v110, v86 row_newbcast:8 row_mask:0xf bank_mask:0xf
  v_dot2c_f32_bf16_dpp v101, v109, v86 row_newbcast:8 row_mask:0xf bank_mask:0xf
  v_dot2c_f32_bf16_dpp v102, v110, v87 row_newbcast:8 row_mask:0xf bank_mask:0xf
  v_dot2c_f32_bf16_dpp v103, v109, v87 row_newbcast:8 row_mask:0xf bank_mask:0xf
  v_dot2c_f32_bf16_dpp v96, v110, v88 row_newbcast:4 row_mask:0xf bank_mask:0xf
  v_dot2c_f32_bf16_dpp v97, v109, v88 row_newbcast:4 row_mask:0xf bank_mask:0xf
  v_dot2c_f32_bf16_dpp v98, v110, v89 row_newbcast:4 row_mask:0xf bank_mask:0xf
  v_dot2c_f32_bf16_dpp v99, v109, v89 row_newbcast:4 row_mask:0xf bank_mask:0xf
  v_dot2c_f32_bf16_dpp v100, v110, v90 row_newbcast:4 row_mask:0xf bank_mask:0xf
  v_dot2c_f32_bf16_dpp v101, v109, v90 row_newbcast:4 row_mask:0xf bank_mask:0xf
  v_dot2c_f32_bf16_dpp v102, v110, v91 row_newbcast:4 row_mask:0xf bank_mask:0xf
  v_dot2c_f32_bf16_dpp v103, v109, v91 row_newbcast:4 row_mask:0xf bank_mask:0xf
  v_dot2c_f32_bf16_dpp v96, v110, v92 row_newbcast:12 row_mask:0xf bank_mask:0xf
  v_dot2c_f32_bf16_dpp v97, v109, v92 row_newbcast:12 row_mask:0xf bank_mask:0xf
  v_dot2c_f32_bf16_dpp v98, v110, v93 row_newbcast:12 row_mask:0xf bank_mask:0xf
  v_dot2c_f32_bf16_dpp v99, v109, v93 row_newbcast:12 row_mask:0xf bank_mask:0xf
  v_dot2c_f32_bf16_dpp v100, v110, v94 row_newbcast:12 row_mask:0xf bank_mask:0xf
  v_dot2c_f32_bf16_dpp v101, v109, v94 row_newbcast:12 row_mask:0xf bank_mask:0xf
  v_dot2c_f32_bf16_dpp v102, v110, v95 row_newbcast:12 row_mask:0xf bank_mask:0xf
  v_dot2c_f32_bf16_dpp v103, v109, v95 row_newbcast:12 row_mask:0xf bank_mask:0xf
  s_branch K1_VDONE
K1_VS:
  s_cmp_ge_u32 s44, 482
  s_cbranch_scc1 K1_VDONE
  s_mov_b64 exec, 1
  ds_add_rtn_u32 v126, v125, v124
  s_mov_b64 exec, -1
  s_lshl_b32 s3, s44, 6
  s_sub_u32 s3, s3, 16384
  v_add_u32 v105, s3, v15
  ds_read_b32 v104, v105 offset:0
  s_waitcnt lgkmcnt(0)
  v_readfirstlane_b32 s74, v126
  v_sub_f32 v104, v104, v112
  v_mul_f32 v104, s63, v104
  v_exp_f32 v104, v104
  s_nop 0
  v_mul_f32 v105, v104, v114
  v_fma_f32 v106, -v105, v113, v104
  v_fma_f32 v105, v106, v114, v105
  v_cvt_pk_bf16_f32 v109, v105, v105
  v_and_b32 v109, s35, v109
  v_lshrrev_b32 v110, 16, v109
  s_waitcnt vmcnt(16)
  s_nop 0
  v_dot2c_f32_bf16_dpp v96, v110, v48 row_newbcast:0 row_mask:0xf bank_mask:0xf
  v_dot2c_f32_bf16_dpp v97, v109, v48 row_newbcast:0 row_mask:0xf bank_mask:0xf
  v_dot2c_f32_bf16_dpp v98, v110, v49 row_newbcast:0 row_mask:0xf bank_mask:0xf
  v_dot2c_f32_bf16_dpp v99, v109, v49 row_newbcast:0 row_mask:0xf bank_mask:0xf
  v_dot2c_f32_bf16_dpp v100, v110, v50 row_newbcast:0 row_mask:0xf bank_mask:0xf
  v_dot2c_f32_bf16_dpp v101, v109, v50 row_newbcast:0 row_mask:0xf bank_mask:0xf
  v_dot2c_f32_bf16_dpp v102, v110, v51 row_newbcast:0 row_mask:0xf bank_mask:0xf
  v_dot2c_f32_bf16_dpp v103, v109, v51 row_newbcast:0 row_mask:0xf bank_mask:0xf
  v_dot2c_f32_bf16_dpp v96, v110, v52 row_newbcast:8 row_mask:0xf bank_mask:0xf
  v_dot2c_f32_bf16_dpp v97, v109, v52 row_newbcast:8 row_mask:0xf bank_mask:0xf
  v_dot2c_f32_bf16_dpp v98, v110, v53 row_newbcast:8 row_mask:0xf bank_mask:0xf
  v_dot2c_f32_bf16_dpp v99, v109, v53 row_newbcast:8 row_mask:0xf bank_mask:0xf
  v_dot2c_f32_bf16_dpp v100, v110, v54 row_newbcast:8 row_mask:0xf bank_mask:0xf
  v_dot2c_f32_bf16_dpp v101, v109, v54 row_newbcast:8 row_mask:0xf bank_mask:0xf
  v_dot2c_f32_bf16_dpp v102, v110, v55 row_newbcast:8 row_mask:0xf bank_mask:0xf
  v_dot2c_f32_bf16_dpp v103, v109, v55 row_newbcast:8 row_mask:0xf bank_mask:0xf
  v_dot2c_f32_bf16_dpp v96, v110, v56 row_newbcast:4 row_mask:0xf bank_mask:0xf
  v_dot2c_f32_bf16_dpp v97, v109, v56 row_newbcast:4 row_mask:0xf bank_mask:0xf
  v_dot2c_f32_bf16_dpp v98, v110, v57 row_newbcast:4 row_mask:0xf bank_mask:0xf
  v_dot2c_f32_bf16_dpp v99, v109, v57 row_newbcast:4 row_mask:0xf bank_mask:0xf
  v_dot2c_f32_bf16_dpp v100, v110, v58 row_newbcast:4 row_mask:0xf bank_mask:0xf
  v_dot2c_f32_bf16_dpp v101, v109, v58 row_newbcast:4 row_mask:0xf bank_mask:0xf
  v_dot2c_f32_bf16_dpp v102, v110, v59 row_newbcast:4 row_mask:0xf bank_mask:0xf
  v_dot2c_f32_bf16_dpp v103, v109, v59 row_newbcast:4 row_mask:0xf bank_mask:0xf
  v_dot2c_f32_bf16_dpp v96, v110, v60 row_newbcast:12 row_mask:0xf bank_mask:0xf
  v_dot2c_f32_bf16_dpp v97, v109, v60 row_newbcast:12 row_mask:0xf bank_mask:0xf
  v_dot2c_f32_bf16_dpp v98, v110, v61 row_newbcast:12 row_mask:0xf bank_mask:0xf
  v_dot2c_f32_bf16_dpp v99, v109, v61 row_newbcast:12 row_mask:0xf bank_mask:0xf
  v_dot2c_f32_bf16_dpp v100, v110, v62 row_newbcast:12 row_mask:0xf bank_mask:0xf
  v_dot2c_f32_bf16_dpp v101, v109, v62 row_newbcast:12 row_mask:0xf bank_mask:0xf
  v_dot2c_f32_bf16_dpp v102, v110, v63 row_newbcast:12 row_mask:0xf bank_mask:0xf
  v_dot2c_f32_bf16_dpp v103, v109, v63 row_newbcast:12 row_mask:0xf bank_mask:0xf
  s_cmp_lt_u32 s74, 256
  s_cselect_b32 s40, s8, s12
  s_cselect_b32 s41, s9, s13
  s_and_b32 s61, s74, 255
  s_lshl_b32 s61, s61, 12
  s_cmp_lt_u32 s74, 482
  s_cselect_b32 s61, s61, 0x100000
  buffer_load_dwordx4 v[48:51], v4, s[40:43], s61 offen offset:0 nt
  buffer_load_dwordx4 v[52:55], v4, s[40:43], s61 offen offset:1024 nt
  buffer_load_dwordx4 v[56:59], v4, s[40:43], s61 offen offset:2048 nt
  buffer_load_dwordx4 v[60:63], v4, s[40:43], s61 offen offset:3072 nt
  s_mov_b32 s44, s74
  s_cmp_ge_u32 s45, 482
  s_cbranch_scc1 K1_VL
  s_lshl_b32 s3, s45, 6
  s_sub_u32 s3, s3, 16384
  v_add_u32 v105, s3, v15
  ds_read_b32 v104, v105 offset:0
  s_waitcnt lgkmcnt(0)
  v_sub_f32 v104, v104, v112
  v_mul_f32 v104, s63, v104
  v_exp_f32 v104, v104
  s_nop 0
  v_mul_f32 v105, v104, v114
  v_fma_f32 v106, -v105, v113, v104
  v_fma_f32 v105, v106, v114, v105
  v_cvt_pk_bf16_f32 v109, v105, v105
  v_and_b32 v109, s35, v109
  v_lshrrev_b32 v110, 16, v109
  s_waitcnt vmcnt(16)
  s_nop 0
  v_dot2c_f32_bf16_dpp v96, v110, v64 row_newbcast:0 row_mask:0xf bank_mask:0xf
  v_dot2c_f32_bf16_dpp v97, v109, v64 row_newbcast:0 row_mask:0xf bank_mask:0xf
  v_dot2c_f32_bf16_dpp v98, v110, v65 row_newbcast:0 row_mask:0xf bank_mask:0xf
  v_dot2c_f32_bf16_dpp v99, v109, v65 row_newbcast:0 row_mask:0xf bank_mask:0xf
  v_dot2c_f32_bf16_dpp v100, v110, v66 row_newbcast:0 row_mask:0xf bank_mask:0xf
  v_dot2c_f32_bf16_dpp v101, v109, v66 row_newbcast:0 row_mask:0xf bank_mask:0xf
  v_dot2c_f32_bf16_dpp v102, v110, v67 row_newbcast:0 row_mask:0xf bank_mask:0xf
  v_dot2c_f32_bf16_dpp v103, v109, v67 row_newbcast:0 row_mask:0xf bank_mask:0xf
  v_dot2c_f32_bf16_dpp v96, v110, v68 row_newbcast:8 row_mask:0xf bank_mask:0xf
  v_dot2c_f32_bf16_dpp v97, v109, v68 row_newbcast:8 row_mask:0xf bank_mask:0xf
  v_dot2c_f32_bf16_dpp v98, v110, v69 row_newbcast:8 row_mask:0xf bank_mask:0xf
  v_dot2c_f32_bf16_dpp v99, v109, v69 row_newbcast:8 row_mask:0xf bank_mask:0xf
  v_dot2c_f32_bf16_dpp v100, v110, v70 row_newbcast:8 row_mask:0xf bank_mask:0xf
  v_dot2c_f32_bf16_dpp v101, v109, v70 row_newbcast:8 row_mask:0xf bank_mask:0xf
  v_dot2c_f32_bf16_dpp v102, v110, v71 row_newbcast:8 row_mask:0xf bank_mask:0xf
  v_dot2c_f32_bf16_dpp v103, v109, v71 row_newbcast:8 row_mask:0xf bank_mask:0xf
  v_dot2c_f32_bf16_dpp v96, v110, v72 row_newbcast:4 row_mask:0xf bank_mask:0xf
  v_dot2c_f32_bf16_dpp v97, v109, v72 row_newbcast:4 row_mask:0xf bank_mask:0xf
  v_dot2c_f32_bf16_dpp v98, v110, v73 row_newbcast:4 row_mask:0xf bank_mask:0xf
  v_dot2c_f32_bf16_dpp v99, v109, v73 row_newbcast:4 row_mask:0xf bank_mask:0xf
  v_dot2c_f32_bf16_dpp v100, v110, v74 row_newbcast:4 row_mask:0xf bank_mask:0xf
  v_dot2c_f32_bf16_dpp v101, v109, v74 row_newbcast:4 row_mask:0xf bank_mask:0xf
  v_dot2c_f32_bf16_dpp v102, v110, v75 row_newbcast:4 row_mask:0xf bank_mask:0xf
  v_dot2c_f32_bf16_dpp v103, v109, v75 row_newbcast:4 row_mask:0xf bank_mask:0xf
  v_dot2c_f32_bf16_dpp v96, v110, v76 row_newbcast:12 row_mask:0xf bank_mask:0xf
  v_dot2c_f32_bf16_dpp v97, v109, v76 row_newbcast:12 row_mask:0xf bank_mask:0xf
  v_dot2c_f32_bf16_dpp v98, v110, v77 row_newbcast:12 row_mask:0xf bank_mask:0xf
  v_dot2c_f32_bf16_dpp v99, v109, v77 row_newbcast:12 row_mask:0xf bank_mask:0xf
  v_dot2c_f32_bf16_dpp v100, v110, v78 row_newbcast:12 row_mask:0xf bank_mask:0xf
  v_dot2c_f32_bf16_dpp v101, v109, v78 row_newbcast:12 row_mask:0xf bank_mask:0xf
  v_dot2c_f32_bf16_dpp v102, v110, v79 row_newbcast:12 row_mask:0xf bank_mask:0xf
  v_dot2c_f32_bf16_dpp v103, v109, v79 row_newbcast:12 row_mask:0xf bank_mask:0xf
  s_cmp_ge_u32 s46, 482
  s_cbranch_scc1 K1_VL
  s_lshl_b32 s3, s46, 6
  s_sub_u32 s3, s3, 16384
  v_add_u32 v105, s3, v15
  ds_read_b32 v104, v105 offset:0
  s_waitcnt lgkmcnt(0)
  v_sub_f32 v104, v104, v112
  v_mul_f32 v104, s63, v104
  v_exp_f32 v104, v104
  s_nop 0
  v_mul_f32 v105, v104, v114
  v_fma_f32 v106, -v105, v113, v104
  v_fma_f32 v105, v106, v114, v105
  v_cvt_pk_bf16_f32 v109, v105, v105
  v_and_b32 v109, s35, v109
  v_lshrrev_b32 v110, 16, v109
  s_waitcnt vmcnt(12)
  s_nop 0
  v_dot2c_f32_bf16_dpp v96, v110, v80 row_newbcast:0 row_mask:0xf bank_mask:0xf
  v_dot2c_f32_bf16_dpp v97, v109, v80 row_newbcast:0 row_mask:0xf bank_mask:0xf
  v_dot2c_f32_bf16_dpp v98, v110, v81 row_newbcast:0 row_mask:0xf bank_mask:0xf
  v_dot2c_f32_bf16_dpp v99, v109, v81 row_newbcast:0 row_mask:0xf bank_mask:0xf
  v_dot2c_f32_bf16_dpp v100, v110, v82 row_newbcast:0 row_mask:0xf bank_mask:0xf
  v_dot2c_f32_bf16_dpp v101, v109, v82 row_newbcast:0 row_mask:0xf bank_mask:0xf
  v_dot2c_f32_bf16_dpp v102, v110, v83 row_newbcast:0 row_mask:0xf bank_mask:0xf
  v_dot2c_f32_bf16_dpp v103, v109, v83 row_newbcast:0 row_mask:0xf bank_mask:0xf
  v_dot2c_f32_bf16_dpp v96, v110, v84 row_newbcast:8 row_mask:0xf bank_mask:0xf
  v_dot2c_f32_bf16_dpp v97, v109, v84 row_newbcast:8 row_mask:0xf bank_mask:0xf
  v_dot2c_f32_bf16_dpp v98, v110, v85 row_newbcast:8 row_mask:0xf bank_mask:0xf
  v_dot2c_f32_bf16_dpp v99, v109, v85 row_newbcast:8 row_mask:0xf bank_mask:0xf
  v_dot2c_f32_bf16_dpp v100, v110, v86 row_newbcast:8 row_mask:0xf bank_mask:0xf
  v_dot2c_f32_bf16_dpp v101, v109, v86 row_newbcast:8 row_mask:0xf bank_mask:0xf
  v_dot2c_f32_bf16_dpp v102, v110, v87 row_newbcast:8 row_mask:0xf bank_mask:0xf
  v_dot2c_f32_bf16_dpp v103, v109, v87 row_newbcast:8 row_mask:0xf bank_mask:0xf
  v_dot2c_f32_bf16_dpp v96, v110, v88 row_newbcast:4 row_mask:0xf bank_mask:0xf
  v_dot2c_f32_bf16_dpp v97, v109, v88 row_newbcast:4 row_mask:0xf bank_mask:0xf
  v_dot2c_f32_bf16_dpp v98, v110, v89 row_newbcast:4 row_mask:0xf bank_mask:0xf
  v_dot2c_f32_bf16_dpp v99, v109, v89 row_newbcast:4 row_mask:0xf bank_mask:0xf
  v_dot2c_f32_bf16_dpp v100, v110, v90 row_newbcast:4 row_mask:0xf bank_mask:0xf
  v_dot2c_f32_bf16_dpp v101, v109, v90 row_newbcast:4 row_mask:0xf bank_mask:0xf
  v_dot2c_f32_bf16_dpp v102, v110, v91 row_newbcast:4 row_mask:0xf bank_mask:0xf
  v_dot2c_f32_bf16_dpp v103, v109, v91 row_newbcast:4 row_mask:0xf bank_mask:0xf
  v_dot2c_f32_bf16_dpp v96, v110, v92 row_newbcast:12 row_mask:0xf bank_mask:0xf
  v_dot2c_f32_bf16_dpp v97, v109, v92 row_newbcast:12 row_mask:0xf bank_mask:0xf
  v_dot2c_f32_bf16_dpp v98, v110, v93 row_newbcast:12 row_mask:0xf bank_mask:0xf
  v_dot2c_f32_bf16_dpp v99, v109, v93 row_newbcast:12 row_mask:0xf bank_mask:0xf
  v_dot2c_f32_bf16_dpp v100, v110, v94 row_newbcast:12 row_mask:0xf bank_mask:0xf
  v_dot2c_f32_bf16_dpp v101, v109, v94 row_newbcast:12 row_mask:0xf bank_mask:0xf
  v_dot2c_f32_bf16_dpp v102, v110, v95 row_newbcast:12 row_mask:0xf bank_mask:0xf
  v_dot2c_f32_bf16_dpp v103, v109, v95 row_newbcast:12 row_mask:0xf bank_mask:0xf
K1_VL:
  s_cmp_ge_u32 s44, 482
  s_cbranch_scc1 K1_VDONE
  s_mov_b64 exec, 1
  ds_add_rtn_u32 v126, v125, v124
  s_mov_b64 exec, -1
  s_lshl_b32 s3, s44, 6
  s_sub_u32 s3, s3, 16384
  v_add_u32 v105, s3, v15
  ds_read_b32 v104, v105 offset:0
  s_waitcnt lgkmcnt(0)
  v_readfirstlane_b32 s74, v126
  v_sub_f32 v104, v104, v112
  v_mul_f32 v104, s63, v104
  v_exp_f32 v104, v104
  s_nop 0
  v_mul_f32 v105, v104, v114
  v_fma_f32 v106, -v105, v113, v104
  v_fma_f32 v105, v106, v114, v105
  v_cvt_pk_bf16_f32 v109, v105, v105
  v_and_b32 v109, s35, v109
  v_lshrrev_b32 v110, 16, v109
  s_waitcnt vmcnt(0)
  s_nop 0
  v_dot2c_f32_bf16_dpp v96, v110, v48 row_newbcast:0 row_mask:0xf bank_mask:0xf
  v_dot2c_f32_bf16_dpp v97, v109, v48 row_newbcast:0 row_mask:0xf bank_mask:0xf
  v_dot2c_f32_bf16_dpp v98, v110, v49 row_newbcast:0 row_mask:0xf bank_mask:0xf
  v_dot2c_f32_bf16_dpp v99, v109, v49 row_newbcast:0 row_mask:0xf bank_mask:0xf
  v_dot2c_f32_bf16_dpp v100, v110, v50 row_newbcast:0 row_mask:0xf bank_mask:0xf
  v_dot2c_f32_bf16_dpp v101, v109, v50 row_newbcast:0 row_mask:0xf bank_mask:0xf
  v_dot2c_f32_bf16_dpp v102, v110, v51 row_newbcast:0 row_mask:0xf bank_mask:0xf
  v_dot2c_f32_bf16_dpp v103, v109, v51 row_newbcast:0 row_mask:0xf bank_mask:0xf
  v_dot2c_f32_bf16_dpp v96, v110, v52 row_newbcast:8 row_mask:0xf bank_mask:0xf
  v_dot2c_f32_bf16_dpp v97, v109, v52 row_newbcast:8 row_mask:0xf bank_mask:0xf
  v_dot2c_f32_bf16_dpp v98, v110, v53 row_newbcast:8 row_mask:0xf bank_mask:0xf
  v_dot2c_f32_bf16_dpp v99, v109, v53 row_newbcast:8 row_mask:0xf bank_mask:0xf
  v_dot2c_f32_bf16_dpp v100, v110, v54 row_newbcast:8 row_mask:0xf bank_mask:0xf
  v_dot2c_f32_bf16_dpp v101, v109, v54 row_newbcast:8 row_mask:0xf bank_mask:0xf
  v_dot2c_f32_bf16_dpp v102, v110, v55 row_newbcast:8 row_mask:0xf bank_mask:0xf
  v_dot2c_f32_bf16_dpp v103, v109, v55 row_newbcast:8 row_mask:0xf bank_mask:0xf
  v_dot2c_f32_bf16_dpp v96, v110, v56 row_newbcast:4 row_mask:0xf bank_mask:0xf
  v_dot2c_f32_bf16_dpp v97, v109, v56 row_newbcast:4 row_mask:0xf bank_mask:0xf
  v_dot2c_f32_bf16_dpp v98, v110, v57 row_newbcast:4 row_mask:0xf bank_mask:0xf
  v_dot2c_f32_bf16_dpp v99, v109, v57 row_newbcast:4 row_mask:0xf bank_mask:0xf
  v_dot2c_f32_bf16_dpp v100, v110, v58 row_newbcast:4 row_mask:0xf bank_mask:0xf
  v_dot2c_f32_bf16_dpp v101, v109, v58 row_newbcast:4 row_mask:0xf bank_mask:0xf
  v_dot2c_f32_bf16_dpp v102, v110, v59 row_newbcast:4 row_mask:0xf bank_mask:0xf
  v_dot2c_f32_bf16_dpp v103, v109, v59 row_newbcast:4 row_mask:0xf bank_mask:0xf
  v_dot2c_f32_bf16_dpp v96, v110, v60 row_newbcast:12 row_mask:0xf bank_mask:0xf
  v_dot2c_f32_bf16_dpp v97, v109, v60 row_newbcast:12 row_mask:0xf bank_mask:0xf
  v_dot2c_f32_bf16_dpp v98, v110, v61 row_newbcast:12 row_mask:0xf bank_mask:0xf
  v_dot2c_f32_bf16_dpp v99, v109, v61 row_newbcast:12 row_mask:0xf bank_mask:0xf
  v_dot2c_f32_bf16_dpp v100, v110, v62 row_newbcast:12 row_mask:0xf bank_mask:0xf
  v_dot2c_f32_bf16_dpp v101, v109, v62 row_newbcast:12 row_mask:0xf bank_mask:0xf
  v_dot2c_f32_bf16_dpp v102, v110, v63 row_newbcast:12 row_mask:0xf bank_mask:0xf
  v_dot2c_f32_bf16_dpp v103, v109, v63 row_newbcast:12 row_mask:0xf bank_mask:0xf
  s_cmp_lt_u32 s74, 256
  s_cselect_b32 s40, s8, s12
  s_cselect_b32 s41, s9, s13
  s_and_b32 s61, s74, 255
  s_lshl_b32 s61, s61, 12
  s_cmp_lt_u32 s74, 482
  s_cselect_b32 s61, s61, 0x100000
  buffer_load_dwordx4 v[48:51], v4, s[40:43], s61 offen offset:0 nt
  buffer_load_dwordx4 v[52:55], v4, s[40:43], s61 offen offset:1024 nt
  buffer_load_dwordx4 v[56:59], v4, s[40:43], s61 offen offset:2048 nt
  buffer_load_dwordx4 v[60:63], v4, s[40:43], s61 offen offset:3072 nt
  s_mov_b32 s44, s74
  s_branch K1_VL
K1_VDONE:
  s_nop 4
  v_permlane32_swap_b32 v96, v97
  v_permlane32_swap_b32 v98, v99
  v_permlane32_swap_b32 v100, v101
  v_permlane32_swap_b32 v102, v103
  v_add_f32 v96, v96, v97
  v_add_f32 v98, v98, v99
  v_add_f32 v100, v100, v101
  v_add_f32 v102, v102, v103
  v_permlane16_swap_b32 v96, v98
  s_nop 0
  v_permlane16_swap_b32 v100, v102
  v_add_f32 v96, v96, v98
  v_add_f32 v100, v100, v102
  ds_write_b32 v14, v96 offset:41216
  ds_write_b32 v14, v100 offset:41232
  s_waitcnt vmcnt(0) lgkmcnt(0)
  s_barrier
  v_and_b32 v104, 7, v1
  s_lshl_b32 s3, s34, 5
  v_lshl_add_u32 v104, v104, 2, s3
  ds_read_b32 v48, v104 offset:41216
  ds_read_b32 v49, v104 offset:41728
  ds_read_b32 v50, v104 offset:42240
  ds_read_b32 v51, v104 offset:42752
  ds_read_b32 v52, v104 offset:43264
  ds_read_b32 v53, v104 offset:43776
  ds_read_b32 v54, v104 offset:44288
  ds_read_b32 v55, v104 offset:44800
  ds_read_b32 v56, v104 offset:45312
  ds_read_b32 v57, v104 offset:45824
  ds_read_b32 v58, v104 offset:46336
  ds_read_b32 v59, v104 offset:46848
  ds_read_b32 v60, v104 offset:47360
  ds_read_b32 v61, v104 offset:47872
  ds_read_b32 v62, v104 offset:48384
  ds_read_b32 v63, v104 offset:48896
  s_waitcnt lgkmcnt(0)
  v_add_f32 v48, v48, v56
  v_add_f32 v49, v49, v57
  v_add_f32 v50, v50, v58
  v_add_f32 v51, v51, v59
  v_add_f32 v52, v52, v60
  v_add_f32 v53, v53, v61
  v_add_f32 v54, v54, v62
  v_add_f32 v55, v55, v63
  v_add_f32 v48, v48, v52
  v_add_f32 v49, v49, v53
  v_add_f32 v50, v50, v54
  v_add_f32 v51, v51, v55
  v_add_f32 v48, v48, v50
  v_add_f32 v49, v49, v51
  v_add_f32 v48, v48, v49
  v_cvt_pk_bf16_f32 v48, v48, v48
  v_and_b32 v48, s35, v48
  s_nop 0
  v_readlane_b32 s64, v48, 0
  v_readlane_b32 s65, v48, 1
  v_readlane_b32 s66, v48, 2
  v_readlane_b32 s67, v48, 3
  v_readlane_b32 s68, v48, 4
  v_readlane_b32 s69, v48, 5
  v_readlane_b32 s70, v48, 6
  v_readlane_b32 s71, v48, 7
  s_lshr_b32 s72, s64, 16
  s_lshr_b32 s73, s65, 16
  s_lshr_b32 s74, s66, 16
  s_lshr_b32 s75, s67, 16
  s_lshr_b32 s76, s68, 16
  s_lshr_b32 s77, s69, 16
  s_lshr_b32 s78, s70, 16
  s_lshr_b32 s79, s71, 16
  v_mov_b32 v96, 0
  v_mov_b32 v97, 0
  v_mov_b32 v98, 0
  v_mov_b32 v99, 0
  v_mov_b32 v100, 0
  v_mov_b32 v101, 0
  v_mov_b32 v102, 0
  v_mov_b32 v103, 0
  v_dot2_f32_bf16 v96, v16, s72, v96
  v_dot2_f32_bf16 v97, v16, s64, v97
  v_dot2_f32_bf16 v98, v17, s72, v98
  v_dot2_f32_bf16 v99, v17, s64, v99
  v_dot2_f32_bf16 v100, v18, s72, v100
  v_dot2_f32_bf16 v101, v18, s64, v101
  v_dot2_f32_bf16 v102, v19, s72, v102
  v_dot2_f32_bf16 v103, v19, s64, v103
  v_dot2_f32_bf16 v96, v20, s73, v96
  v_dot2_f32_bf16 v97, v20, s65, v97
  v_dot2_f32_bf16 v98, v21, s73, v98
  v_dot2_f32_bf16 v99, v21, s65, v99
  v_dot2_f32_bf16 v100, v22, s73, v100
  v_dot2_f32_bf16 v101, v22, s65, v101
  v_dot2_f32_bf16 v102, v23, s73, v102
  v_dot2_f32_bf16 v103, v23, s65, v103
  v_dot2_f32_bf16 v96, v24, s74, v96
  v_dot2_f32_bf16 v97, v24, s66, v97
  v_dot2_f32_bf16 v98, v25, s74, v98
  v_dot2_f32_bf16 v99, v25, s66, v99
  v_dot2_f32_bf16 v100, v26, s74, v100
  v_dot2_f32_bf16 v101, v26, s66, v101
  v_dot2_f32_bf16 v102, v27, s74, v102
  v_dot2_f32_bf16 v103, v27, s66, v103
  v_dot2_f32_bf16 v96, v28, s75, v96
  v_dot2_f32_bf16 v97, v28, s67, v97
  v_dot2_f32_bf16 v98, v29, s75, v98
  v_dot2_f32_bf16 v99, v29, s67, v99
  v_dot2_f32_bf16 v100, v30, s75, v100
  v_dot2_f32_bf16 v101, v30, s67, v101
  v_dot2_f32_bf16 v102, v31, s75, v102
  v_dot2_f32_bf16 v103, v31, s67, v103
  v_dot2_f32_bf16 v96, v32, s76, v96
  v_dot2_f32_bf16 v97, v32, s68, v97
  v_dot2_f32_bf16 v98, v33, s76, v98
  v_dot2_f32_bf16 v99, v33, s68, v99
  v_dot2_f32_bf16 v100, v34, s76, v100
  v_dot2_f32_bf16 v101, v34, s68, v101
  v_dot2_f32_bf16 v102, v35, s76, v102
  v_dot2_f32_bf16 v103, v35, s68, v103
  v_dot2_f32_bf16 v96, v36, s77, v96
  v_dot2_f32_bf16 v97, v36, s69, v97
  v_dot2_f32_bf16 v98, v37, s77, v98
  v_dot2_f32_bf16 v99, v37, s69, v99
  v_dot2_f32_bf16 v100, v38, s77, v100
  v_dot2_f32_bf16 v101, v38, s69, v101
  v_dot2_f32_bf16 v102, v39, s77, v102
  v_dot2_f32_bf16 v103, v39, s69, v103
  v_dot2_f32_bf16 v96, v40, s78, v96
  v_dot2_f32_bf16 v97, v40, s70, v97
  v_dot2_f32_bf16 v98, v41, s78, v98
  v_dot2_f32_bf16 v99, v41, s70, v99
  v_dot2_f32_bf16 v100, v42, s78, v100
  v_dot2_f32_bf16 v101, v42, s70, v101
  v_dot2_f32_bf16 v102, v43, s78, v102
  v_dot2_f32_bf16 v103, v43, s70, v103
  v_dot2_f32_bf16 v96, v44, s79, v96
  v_dot2_f32_bf16 v97, v44, s71, v97
  v_dot2_f32_bf16 v98, v45, s79, v98
  v_dot2_f32_bf16 v99, v45, s71, v99
  v_dot2_f32_bf16 v100, v46, s79, v100
  v_dot2_f32_bf16 v101, v46, s71, v101
  v_dot2_f32_bf16 v102, v47, s79, v102
  v_dot2_f32_bf16 v103, v47, s71, v103
  s_lshl_b32 s3, s34, 11
  v_lshl_add_u32 v104, v1, 5, s3
  ds_write_b128 v104, v[96:99] offset:0
  ds_write_b128 v104, v[100:103] offset:16
  s_waitcnt lgkmcnt(0)
  s_barrier
  s_cmp_ge_u32 s34, 8
  s_cbranch_scc1 K1_SKIP_PART
  v_lshlrev_b32 v104, 2, v0
  ds_read_b32 v48, v104 offset:0
  ds_read_b32 v49, v104 offset:2048
  ds_read_b32 v50, v104 offset:4096
  ds_read_b32 v51, v104 offset:6144
  ds_read_b32 v52, v104 offset:8192
  ds_read_b32 v53, v104 offset:10240
  ds_read_b32 v54, v104 offset:12288
  ds_read_b32 v55, v104 offset:14336
  ds_read_b32 v56, v104 offset:16384
  ds_read_b32 v57, v104 offset:18432
  ds_read_b32 v58, v104 offset:20480
  ds_read_b32 v59, v104 offset:22528
  ds_read_b32 v60, v104 offset:24576
  ds_read_b32 v61, v104 offset:26624
  ds_read_b32 v62, v104 offset:28672
  ds_read_b32 v63, v104 offset:30720
  s_waitcnt lgkmcnt(0)
  v_add_f32 v48, v48, v56
  v_add_f32 v49, v49, v57
  v_add_f32 v50, v50, v58
  v_add_f32 v51, v51, v59
  v_add_f32 v52, v52, v60
  v_add_f32 v53, v53, v61
  v_add_f32 v54, v54, v62
  v_add_f32 v55, v55, v63
  v_add_f32 v48, v48, v52
  v_add_f32 v49, v49, v53
  v_add_f32 v50, v50, v54
  v_add_f32 v51, v51, v55
  v_add_f32 v48, v48, v50
  v_add_f32 v49, v49, v51
  v_add_f32 v48, v48, v49
  s_lshl_b32 s3, s2, 11
  buffer_store_dword v48, v104, s[24:27], s3 offen offset:0 sc1
  s_waitcnt vmcnt(0)
K1_SKIP_PART:
  s_barrier
  s_cmp_lg_u32 s34, 0
  s_cbranch_scc1 K1_SKIP_ATOM
  s_mov_b64 exec, 1
  v_mov_b32 v104, 1
  v_mov_b32 v105, 1
  s_lshl_b32 s3, s32, 2
  v_mov_b32 v106, s3
  v_mov_b32 v107, 64
  buffer_atomic_add v104, v106, s[28:31], 0 offen sc0
  buffer_atomic_add v105, v107, s[28:31], 0 offen sc0
  s_waitcnt vmcnt(0)
  v_mov_b32 v106, 0
  ds_write_b64 v106, v[104:105] offset:49408
  s_waitcnt lgkmcnt(0)
  s_mov_b64 exec, -1
K1_SKIP_ATOM:
  s_barrier
  v_mov_b32 v106, 0
  ds_read_b64 v[104:105], v106 offset:49408
  s_waitcnt lgkmcnt(0)
  v_readfirstlane_b32 s3, v104
  v_readfirstlane_b32 s77, v105
  s_cmp_lg_u32 s3, 31
  s_cbranch_scc1 K1_AFTER_BATCH
  v_and_b32 v104, 127, v0
  v_lshrrev_b32 v105, 7, v0
  v_lshlrev_b32 v106, 13, v105
  v_lshl_add_u32 v106, v104, 4, v106
  s_lshl_b32 s3, s32, 16
  s_add_u32 s62, s3, 4096
  buffer_load_dwordx4 v[48:51], v106, s[24:27], s3 offen offset:0 sc1
  buffer_load_dwordx4 v[52:55], v106, s[24:27], s3 offen offset:2048 sc1
  buffer_load_dwordx4 v[56:59], v106, s[24:27], s62 offen offset:0 sc1
  buffer_load_dwordx4 v[60:63], v106, s[24:27], s62 offen offset:2048 sc1
  s_waitcnt vmcnt(0)
  v_add_f32 v48, v48, v52
  v_add_f32 v56, v56, v60
  v_add_f32 v48, v48, v56
  v_add_f32 v49, v49, v53
  v_add_f32 v57, v57, v61
  v_add_f32 v49, v49, v57
  v_add_f32 v50, v50, v54
  v_add_f32 v58, v58, v62
  v_add_f32 v50, v50, v58
  v_add_f32 v51, v51, v55
  v_add_f32 v59, v59, v63
  v_add_f32 v51, v51, v59
  v_lshlrev_b32 v105, 11, v105
  v_lshl_add_u32 v105, v104, 4, v105
  ds_write_b128 v105, v[48:51] offset:32768
  s_waitcnt lgkmcnt(0)
  s_barrier
  s_cmp_lg_u32 s34, 0
  s_cbranch_scc1 K1_AFTER_BATCH
  v_lshlrev_b32 v104, 5, v1
  ds_read_b128 v[16:19], v104 offset:32768
  ds_read_b128 v[20:23], v104 offset:32784
  ds_read_b128 v[24:27], v104 offset:34816
  ds_read_b128 v[28:31], v104 offset:34832
  ds_read_b128 v[32:35], v104 offset:36864
  ds_read_b128 v[36:39], v104 offset:36880
  ds_read_b128 v[40:43], v104 offset:38912
  ds_read_b128 v[44:47], v104 offset:38928
  ds_read_b128 v[48:51], v104 offset:40960
  ds_read_b128 v[52:55], v104 offset:40976
  ds_read_b128 v[56:59], v104 offset:43008
  ds_read_b128 v[60:63], v104 offset:43024
  ds_read_b128 v[64:67], v104 offset:45056
  ds_read_b128 v[68:71], v104 offset:45072
  ds_read_b128 v[72:75], v104 offset:47104
  ds_read_b128 v[76:79], v104 offset:47120
  s_waitcnt lgkmcnt(0)
  v_add_f32 v16, v16, v48
  v_add_f32 v17, v17, v49
  v_add_f32 v18, v18, v50
  v_add_f32 v19, v19, v51
  v_add_f32 v20, v20, v52
  v_add_f32 v21, v21, v53
  v_add_f32 v22, v22, v54
  v_add_f32 v23, v23, v55
  v_add_f32 v24, v24, v56
  v_add_f32 v25, v25, v57
  v_add_f32 v26, v26, v58
  v_add_f32 v27, v27, v59
  v_add_f32 v28, v28, v60
  v_add_f32 v29, v29, v61
  v_add_f32 v30, v30, v62
  v_add_f32 v31, v31, v63
  v_add_f32 v32, v32, v64
  v_add_f32 v33, v33, v65
  v_add_f32 v34, v34, v66
  v_add_f32 v35, v35, v67
  v_add_f32 v36, v36, v68
  v_add_f32 v37, v37, v69
  v_add_f32 v38, v38, v70
  v_add_f32 v39, v39, v71
  v_add_f32 v40, v40, v72
  v_add_f32 v41, v41, v73
  v_add_f32 v42, v42, v74
  v_add_f32 v43, v43, v75
  v_add_f32 v44, v44, v76
  v_add_f32 v45, v45, v77
  v_add_f32 v46, v46, v78
  v_add_f32 v47, v47, v79
  v_add_f32 v16, v16, v32
  v_add_f32 v17, v17, v33
  v_add_f32 v18, v18, v34
  v_add_f32 v19, v19, v35
  v_add_f32 v20, v20, v36
  v_add_f32 v21, v21, v37
  v_add_f32 v22, v22, v38
  v_add_f32 v23, v23, v39
  v_add_f32 v24, v24, v40
  v_add_f32 v25, v25, v41
  v_add_f32 v26, v26, v42
  v_add_f32 v27, v27, v43
  v_add_f32 v28, v28, v44
  v_add_f32 v29, v29, v45
  v_add_f32 v30, v30, v46
  v_add_f32 v31, v31, v47
  v_add_f32 v16, v16, v24
  v_add_f32 v17, v17, v25
  v_add_f32 v18, v18, v26
  v_add_f32 v19, v19, v27
  v_add_f32 v20, v20, v28
  v_add_f32 v21, v21, v29
  v_add_f32 v22, v22, v30
  v_add_f32 v23, v23, v31
  v_cvt_pk_bf16_f32 v16, v16, v16
  v_and_b32 v16, s35, v16
  v_cvt_pk_bf16_f32 v17, v17, v17
  v_and_b32 v17, s35, v17
  v_cvt_pk_bf16_f32 v18, v18, v18
  v_and_b32 v18, s35, v18
  v_cvt_pk_bf16_f32 v19, v19, v19
  v_and_b32 v19, s35, v19
  v_cvt_pk_bf16_f32 v20, v20, v20
  v_and_b32 v20, s35, v20
  v_cvt_pk_bf16_f32 v21, v21, v21
  v_and_b32 v21, s35, v21
  v_cvt_pk_bf16_f32 v22, v22, v22
  v_and_b32 v22, s35, v22
  v_cvt_pk_bf16_f32 v23, v23, v23
  v_and_b32 v23, s35, v23
  v_lshlrev_b32 v24, 16, v10
  v_and_b32 v25, s35, v10
  v_lshlrev_b32 v26, 16, v11
  v_and_b32 v27, s35, v11
  v_lshlrev_b32 v28, 16, v12
  v_and_b32 v29, s35, v12
  v_lshlrev_b32 v30, 16, v13
  v_and_b32 v31, s35, v13
  v_add_f32 v24, v24, v16
  v_add_f32 v25, v25, v17
  v_add_f32 v26, v26, v18
  v_add_f32 v27, v27, v19
  v_add_f32 v28, v28, v20
  v_add_f32 v29, v29, v21
  v_add_f32 v30, v30, v22
  v_add_f32 v31, v31, v23
  v_cvt_pk_bf16_f32 v32, v24, v25
  v_cvt_pk_bf16_f32 v33, v26, v27
  v_cvt_pk_bf16_f32 v34, v28, v29
  v_cvt_pk_bf16_f32 v35, v30, v31
  v_lshlrev_b32 v24, 16, v32
  v_and_b32 v25, s35, v32
  v_lshlrev_b32 v26, 16, v33
  v_and_b32 v27, s35, v33
  v_lshlrev_b32 v28, 16, v34
  v_and_b32 v29, s35, v34
  v_lshlrev_b32 v30, 16, v35
  v_and_b32 v31, s35, v35
  s_lshl_b32 s3, s32, 10
  s_add_u32 s3, s3, 524288
  buffer_store_dwordx4 v[32:35], v4, s[24:27], s3 offen sc1
  v_add_f32 v40, v24, v25
  v_add_f32 v41, v26, v27
  v_add_f32 v40, v40, v28
  v_add_f32 v41, v41, v29
  v_add_f32 v40, v40, v30
  v_add_f32 v41, v41, v31
  v_add_f32 v40, v40, v41
  s_nop 1
  v_add_f32_dpp v42, v40, v40 quad_perm:[1,0,3,2] row_mask:0xf bank_mask:0xf
  s_nop 1
  v_add_f32_dpp v43, v42, v42 quad_perm:[2,3,0,1] row_mask:0xf bank_mask:0xf
  s_nop 1
  v_add_f32_dpp v42, v43, v43 row_half_mirror row_mask:0xf bank_mask:0xf
  s_nop 1
  v_add_f32_dpp v43, v42, v42 row_mirror row_mask:0xf bank_mask:0xf
  s_nop 0
  v_readlane_b32 s64, v43, 0
  v_readlane_b32 s65, v43, 16
  v_readlane_b32 s66, v43, 32
  v_readlane_b32 s67, v43, 48
  v_mov_b32 v44, s64
  v_add_f32 v44, s65, v44
  v_add_f32 v44, s66, v44
  v_add_f32 v44, s67, v44
  v_mul_f32 v44, 0x3b000000, v44
  v_mov_b32 v40, 0
  v_mov_b32 v41, 0
  v_sub_f32 v48, v24, v44
  v_sub_f32 v49, v25, v44
  v_fmac_f32 v40, v48, v48
  v_fmac_f32 v41, v49, v49
  v_sub_f32 v48, v26, v44
  v_sub_f32 v49, v27, v44
  v_fmac_f32 v40, v48, v48
  v_fmac_f32 v41, v49, v49
  v_sub_f32 v48, v28, v44
  v_sub_f32 v49, v29, v44
  v_fmac_f32 v40, v48, v48
  v_fmac_f32 v41, v49, v49
  v_sub_f32 v48, v30, v44
  v_sub_f32 v49, v31, v44
  v_fmac_f32 v40, v48, v48
  v_fmac_f32 v41, v49, v49
  v_add_f32 v40, v40, v41
  s_nop 1
  v_add_f32_dpp v42, v40, v40 quad_perm:[1,0,3,2] row_mask:0xf bank_mask:0xf
  s_nop 1
  v_add_f32_dpp v43, v42, v42 quad_perm:[2,3,0,1] row_mask:0xf bank_mask:0xf
  s_nop 1
  v_add_f32_dpp v42, v43, v43 row_half_mirror row_mask:0xf bank_mask:0xf
  s_nop 1
  v_add_f32_dpp v43, v42, v42 row_mirror row_mask:0xf bank_mask:0xf
  s_nop 0
  v_readlane_b32 s64, v43, 0
  v_readlane_b32 s65, v43, 16
  v_readlane_b32 s66, v43, 32
  v_readlane_b32 s67, v43, 48
  v_mov_b32 v46, s64
  v_add_f32 v46, s65, v46
  v_add_f32 v46, s66, v46
  v_add_f32 v46, s67, v46
  v_mul_f32 v46, 0x3b000000, v46
  v_cvt_pk_bf16_f32 v46, v46, v46
  v_and_b32 v46, s35, v46
  v_add_f32 v46, 0x3727c5ac, v46
  v_cvt_pk_bf16_f32 v46, v46, v46
  v_and_b32 v46, s35, v46
  v_sqrt_f32 v46, v46
  s_nop 0
  v_cvt_pk_bf16_f32 v46, v46, v46
  v_and_b32 v46, s35, v46
  v_cvt_pk_bf16_f32 v45, v44, v44
  v_and_b32 v45, s35, v45
  v_rcp_f32 v47, v46
  v_sub_f32 v48, v24, v45
  v_cvt_pk_bf16_f32 v48, v48, v48
  v_and_b32 v48, s35, v48
  v_mul_f32 v49, v48, v47
  v_fma_f32 v50, -v49, v46, v48
  v_fma_f32 v49, v50, v47, v49
  v_cvt_pk_bf16_f32 v24, v49, v49
  v_and_b32 v24, s35, v24
  v_sub_f32 v48, v25, v45
  v_cvt_pk_bf16_f32 v48, v48, v48
  v_and_b32 v48, s35, v48
  v_mul_f32 v49, v48, v47
  v_fma_f32 v50, -v49, v46, v48
  v_fma_f32 v49, v50, v47, v49
  v_cvt_pk_bf16_f32 v25, v49, v49
  v_and_b32 v25, s35, v25
  v_sub_f32 v48, v26, v45
  v_cvt_pk_bf16_f32 v48, v48, v48
  v_and_b32 v48, s35, v48
  v_mul_f32 v49, v48, v47
  v_fma_f32 v50, -v49, v46, v48
  v_fma_f32 v49, v50, v47, v49
  v_cvt_pk_bf16_f32 v26, v49, v49
  v_and_b32 v26, s35, v26
  v_sub_f32 v48, v27, v45
  v_cvt_pk_bf16_f32 v48, v48, v48
  v_and_b32 v48, s35, v48
  v_mul_f32 v49, v48, v47
  v_fma_f32 v50, -v49, v46, v48
  v_fma_f32 v49, v50, v47, v49
  v_cvt_pk_bf16_f32 v27, v49, v49
  v_and_b32 v27, s35, v27
  v_sub_f32 v48, v28, v45
  v_cvt_pk_bf16_f32 v48, v48, v48
  v_and_b32 v48, s35, v48
  v_mul_f32 v49, v48, v47
  v_fma_f32 v50, -v49, v46, v48
  v_fma_f32 v49, v50, v47, v49
  v_cvt_pk_bf16_f32 v28, v49, v49
  v_and_b32 v28, s35, v28
  v_sub_f32 v48, v29, v45
  v_cvt_pk_bf16_f32 v48, v48, v48
  v_and_b32 v48, s35, v48
  v_mul_f32 v49, v48, v47
  v_fma_f32 v50, -v49, v46, v48
  v_fma_f32 v49, v50, v47, v49
  v_cvt_pk_bf16_f32 v29, v49, v49
  v_and_b32 v29, s35, v29
  v_sub_f32 v48, v30, v45
  v_cvt_pk_bf16_f32 v48, v48, v48
  v_and_b32 v48, s35, v48
  v_mul_f32 v49, v48, v47
  v_fma_f32 v50, -v49, v46, v48
  v_fma_f32 v49, v50, v47, v49
  v_cvt_pk_bf16_f32 v30, v49, v49
  v_and_b32 v30, s35, v30
  v_sub_f32 v48, v31, v45
  v_cvt_pk_bf16_f32 v48, v48, v48
  v_and_b32 v48, s35, v48
  v_mul_f32 v49, v48, v47
  v_fma_f32 v50, -v49, v46, v48
  v_fma_f32 v49, v50, v47, v49
  v_cvt_pk_bf16_f32 v31, v49, v49
  v_and_b32 v31, s35, v31
  v_cvt_pk_bf16_f32 v64, v24, v25
  v_cvt_pk_bf16_f32 v65, v26, v27
  v_cvt_pk_bf16_f32 v66, v28, v29
  v_cvt_pk_bf16_f32 v67, v30, v31
  s_lshl_b32 s3, s32, 10
  s_add_u32 s3, s3, 532480
  buffer_store_dwordx4 v[64:67], v4, s[24:27], s3 offen sc1
  s_waitcnt vmcnt(0)
  s_mov_b64 exec, 1
  v_mov_b32 v104, 1
  v_mov_b32 v105, 128
  buffer_atomic_add v104, v105, s[28:31], 0 offen
  s_mov_b64 exec, -1
K1_AFTER_BATCH:
  s_cmp_ge_u32 s77, 86
  s_cbranch_scc1 K1_END2
  s_mov_b32 s20, s52
  s_and_b32 s21, s53, 0xffff
  s_mov_b32 s22, 1409024
  s_mov_b32 s23, 0x00020000
  s_mov_b32 s36, s54
  s_and_b32 s37, s55, 0xffff
  s_mov_b32 s38, 8192
  s_mov_b32 s39, 0x00020000
  s_add_u32 s60, s58, 1048576
  s_addc_u32 s61, s59, 0
  s_mov_b32 s16, s60
  s_and_b32 s17, s61, 0xffff
  s_mov_b32 s18, 1409024
  s_mov_b32 s19, 0x00020000
  v_and_b32 v5, 7, v0
  v_lshrrev_b32 v6, 3, v1
  v_lshlrev_b32 v7, 4, v0
  v_lshrrev_b32 v8, 6, v0
  s_cmp_lg_u32 s34, 0
  s_cbranch_scc1 K1_PDa
  v_mov_b32 v105, 192
K1_PLa:
  buffer_load_dword v104, v105, s[28:31], 0 offen sc1
  s_waitcnt vmcnt(0)
  v_readfirstlane_b32 s3, v104
  s_cmp_ge_u32 s3, 256
  s_cbranch_scc1 K1_PDa
  s_sleep 1
  s_branch K1_PLa
K1_PDa:
  s_barrier
  s_lshl_b32 s78, s77, 14
  s_lshl_b32 s60, s77, 15
  s_lshl_b32 s61, s34, 10
  s_add_u32 s60, s60, s61
  s_add_u32 s60, s60, 2621440
  s_add_u32 s61, s60, 16384
  buffer_load_dwordx4 v[32:35], v4, s[24:27], s60 offen sc1
  buffer_load_dwordx4 v[36:39], v4, s[24:27], s61 offen sc1
  buffer_load_dwordx4 v[40:43], v7, s[20:23], s78 offen
  v_and_b32 v118, 7, v1
  v_lshlrev_b32 v118, 10, v118
  v_lshl_add_u32 v118, v3, 4, v118
  s_lshl_b32 s62, s34, 6
  s_add_u32 s62, s62, 532480
  v_lshlrev_b32 v119, 8, v3
  v_lshl_add_u32 v119, v2, 2, v119
  v_lshl_add_u32 v119, v8, 10, v119
  v_lshrrev_b32 v124, 2, v1
  v_lshlrev_b32 v124, 10, v124
  v_and_b32 v125, 3, v1
  v_lshl_add_u32 v124, v125, 3, v124
  v_lshl_add_u32 v124, v8, 6, v124
  s_waitcnt vmcnt(0)
  ds_write_b128 v7, v[40:43] offset:16896
  s_cmp_lg_u32 s34, 0
  s_cbranch_scc1 K1_PDb
  v_mov_b32 v117, 128
K1_PLb:
  buffer_load_dword v116, v117, s[28:31], 0 offen sc1
  s_waitcnt vmcnt(0)
  v_readfirstlane_b32 s3, v116
  s_cmp_ge_u32 s3, 8
  s_cbranch_scc1 K1_PDb
  s_sleep 1
  s_branch K1_PLb
K1_PDb:
  s_waitcnt lgkmcnt(0)
  s_barrier
  buffer_load_dwordx4 v[16:19], v118, s[24:27], s62 offen sc1
  ds_read_b64_tr_b16 v[44:45], v124 offset:16896
  ds_read_b64_tr_b16 v[46:47], v124 offset:16928
  s_waitcnt vmcnt(0)
  v_mfma_f32_16x16x32_bf16 v[20:23], v[16:19], v[32:35], 0
  v_mfma_f32_16x16x32_bf16 v[24:27], v[16:19], v[36:39], 0
  s_mov_b32 s66, -1
  s_mov_b32 s67, 0
  s_nop 7
  s_nop 3
  s_mov_b64 exec, s[66:67]
  ds_write_b32 v119, v20 offset:0
  ds_write_b32 v119, v24 offset:512
  ds_write_b32 v119, v21 offset:64
  ds_write_b32 v119, v25 offset:576
  ds_write_b32 v119, v22 offset:128
  ds_write_b32 v119, v26 offset:640
  ds_write_b32 v119, v23 offset:192
  ds_write_b32 v119, v27 offset:704
  s_mov_b64 exec, -1
  s_waitcnt lgkmcnt(0)
  s_barrier
  s_cmp_ge_u32 s34, 2
  s_cbranch_scc1 K1_SKIP_ACT
  v_lshlrev_b32 v116, 2, v0
  ds_read2st64_b32 v[72:73], v116 offset0:0 offset1:2
  ds_read2st64_b32 v[74:75], v116 offset0:4 offset1:6
  ds_read2st64_b32 v[76:77], v116 offset0:8 offset1:10
  ds_read2st64_b32 v[78:79], v116 offset0:12 offset1:14
  ds_read2st64_b32 v[80:81], v116 offset0:16 offset1:18
  ds_read2st64_b32 v[82:83], v116 offset0:20 offset1:22
  ds_read2st64_b32 v[84:85], v116 offset0:24 offset1:26
  ds_read2st64_b32 v[86:87], v116 offset0:28 offset1:30
  ds_read2st64_b32 v[88:89], v116 offset0:32 offset1:34
  ds_read2st64_b32 v[90:91], v116 offset0:36 offset1:38
  ds_read2st64_b32 v[92:93], v116 offset0:40 offset1:42
  ds_read2st64_b32 v[94:95], v116 offset0:44 offset1:46
  ds_read2st64_b32 v[96:97], v116 offset0:48 offset1:50
  ds_read2st64_b32 v[98:99], v116 offset0:52 offset1:54
  ds_read2st64_b32 v[100:101], v116 offset0:56 offset1:58
  ds_read2st64_b32 v[102:103], v116 offset0:60 offset1:62
  s_waitcnt lgkmcnt(0)
  v_add_f32 v72, v72, v88
  v_add_f32 v73, v73, v89
  v_add_f32 v74, v74, v90
  v_add_f32 v75, v75, v91
  v_add_f32 v76, v76, v92
  v_add_f32 v77, v77, v93
  v_add_f32 v78, v78, v94
  v_add_f32 v79, v79, v95
  v_add_f32 v80, v80, v96
  v_add_f32 v81, v81, v97
  v_add_f32 v82, v82, v98
  v_add_f32 v83, v83, v99
  v_add_f32 v84, v84, v100
  v_add_f32 v85, v85, v101
  v_add_f32 v86, v86, v102
  v_add_f32 v87, v87, v103
  v_add_f32 v72, v72, v80
  v_add_f32 v73, v73, v81
  v_add_f32 v74, v74, v82
  v_add_f32 v75, v75, v83
  v_add_f32 v76, v76, v84
  v_add_f32 v77, v77, v85
  v_add_f32 v78, v78, v86
  v_add_f32 v79, v79, v87
  v_add_f32 v72, v72, v76
  v_add_f32 v73, v73, v77
  v_add_f32 v74, v74, v78
  v_add_f32 v75, v75, v79
  v_add_f32 v72, v72, v74
  v_add_f32 v73, v73, v75
  v_cvt_pk_bf16_f32 v72, v72, v72
  v_and_b32 v72, s35, v72
  v_cvt_pk_bf16_f32 v73, v73, v73
  v_and_b32 v73, s35, v73
  v_mul_f32 v120, 0xbfb8aa3b, v72
  v_exp_f32 v120, v120
  s_nop 0
  v_add_f32 v120, 1.0, v120
  v_rcp_f32 v121, v120
  s_nop 0
  v_mul_f32 v122, v72, v121
  v_fma_f32 v123, -v122, v120, v72
  v_fma_f32 v123, v123, v121, v122
  v_cmp_u_f32 vcc, v123, v123
  s_nop 1
  v_cndmask_b32 v122, v123, v122, vcc
  v_cvt_pk_bf16_f32 v122, v122, v122
  v_and_b32 v122, s35, v122
  v_mul_f32 v122, v122, v73
  v_cvt_pk_bf16_f32 v122, v122, v122
  v_lshlrev_b32 v116, 1, v0
  ds_write_b16 v116, v122 offset:16384
  s_waitcnt lgkmcnt(0)
K1_SKIP_ACT:
  s_barrier
  v_and_b32 v116, 7, v1
  v_lshlrev_b32 v116, 5, v116
  v_lshl_add_u32 v116, v3, 3, v116
  ds_read_b64 v[16:17], v116 offset:16384
  v_lshlrev_b32 v120, 11, v2
  v_lshl_add_u32 v120, v3, 4, v120
  v_lshl_add_u32 v120, v8, 7, v120
  v_cmp_gt_u32 vcc, 8, v2
  s_waitcnt lgkmcnt(0)
  v_mfma_f32_16x16x16_bf16 v[20:23], v[44:45], v[16:17], 0
  v_mfma_f32_16x16x16_bf16 v[24:27], v[46:47], v[16:17], 0
  s_nop 7
  s_nop 3
  s_and_saveexec_b64 s[66:67], vcc
  buffer_store_dwordx4 v[20:23], v120, s[16:19], s78 offen sc1
  buffer_store_dwordx4 v[24:27], v120, s[16:19], s78 offen offset:64 sc1
  s_mov_b64 exec, s[66:67]
  s_waitcnt vmcnt(0)
  s_barrier
  s_cmp_lg_u32 s34, 0
  s_cbranch_scc1 K1_NOCD
  s_mov_b64 exec, 1
  v_mov_b32 v116, 1
  v_mov_b32 v117, 160
  buffer_atomic_add v116, v117, s[28:31], 0 offen
  s_mov_b64 exec, -1
K1_NOCD:
  s_cmp_ge_u32 s77, 64
  s_cbranch_scc1 K1_END2
  s_cmp_lg_u32 s34, 0
  s_cbranch_scc1 K1_PDc
  v_mov_b32 v117, 160
K1_PLc:
  buffer_load_dword v116, v117, s[28:31], 0 offen sc1
  s_waitcnt vmcnt(0)
  v_readfirstlane_b32 s3, v116
  s_cmp_ge_u32 s3, 86
  s_cbranch_scc1 K1_PDc
  s_sleep 1
  s_branch K1_PLc
K1_PDc:
  s_waitcnt lgkmcnt(0)
  s_barrier
  v_lshlrev_b32 v118, 14, v8
  v_lshl_add_u32 v118, v1, 2, v118
  s_lshl_b32 s3, s77, 8
  buffer_load_dword v16, v118, s[16:19], s3 offen sc1
  s_add_u32 s3, s3, 262144
  buffer_load_dword v17, v118, s[16:19], s3 offen sc1
  s_add_u32 s3, s3, 262144
  buffer_load_dword v18, v118, s[16:19], s3 offen sc1
  s_add_u32 s3, s3, 262144
  buffer_load_dword v19, v118, s[16:19], s3 offen sc1
  s_add_u32 s3, s3, 262144
  buffer_load_dword v20, v118, s[16:19], s3 offen sc1
  s_add_u32 s3, s3, 262144
  buffer_load_dword v21, v118, s[16:19], s3 offen sc1
  v_lshlrev_b32 v119, 2, v0
  s_lshl_b32 s3, s77, 7
  s_add_u32 s62, s3, 524288
  buffer_load_dword v24, v119, s[24:27], s62 offen sc1
  s_waitcnt vmcnt(1)
  v_add_f32 v16, v16, v17
  v_add_f32 v18, v18, v19
  v_add_f32 v20, v20, v21
  v_add_f32 v16, v16, v18
  v_add_f32 v16, v16, v20
  ds_write_b32 v119, v16 offset:41472
  s_waitcnt lgkmcnt(0)
  s_barrier
  s_cmp_lg_u32 s34, 0
  s_cbranch_scc1 K1_END2
  s_mov_b32 s66, -1
  s_mov_b32 s67, 0
  s_mov_b64 exec, s[66:67]
  v_lshlrev_b32 v120, 3, v0
  ds_read_b64 v[32:33], v120 offset:41472
  ds_read_b64 v[34:35], v120 offset:41728
  ds_read_b64 v[36:37], v120 offset:41984
  ds_read_b64 v[38:39], v120 offset:42240
  ds_read_b64 v[40:41], v120 offset:42496
  ds_read_b64 v[42:43], v120 offset:42752
  ds_read_b64 v[44:45], v120 offset:43008
  ds_read_b64 v[46:47], v120 offset:43264
  ds_read_b64 v[48:49], v120 offset:43520
  ds_read_b64 v[50:51], v120 offset:43776
  ds_read_b64 v[52:53], v120 offset:44032
  ds_read_b64 v[54:55], v120 offset:44288
  ds_read_b64 v[56:57], v120 offset:44544
  ds_read_b64 v[58:59], v120 offset:44800
  ds_read_b64 v[60:61], v120 offset:45056
  ds_read_b64 v[62:63], v120 offset:45312
  s_waitcnt vmcnt(0) lgkmcnt(0)
  v_add_f32 v32, v32, v48
  v_add_f32 v33, v33, v49
  v_add_f32 v34, v34, v50
  v_add_f32 v35, v35, v51
  v_add_f32 v36, v36, v52
  v_add_f32 v37, v37, v53
  v_add_f32 v38, v38, v54
  v_add_f32 v39, v39, v55
  v_add_f32 v40, v40, v56
  v_add_f32 v41, v41, v57
  v_add_f32 v42, v42, v58
  v_add_f32 v43, v43, v59
  v_add_f32 v44, v44, v60
  v_add_f32 v45, v45, v61
  v_add_f32 v46, v46, v62
  v_add_f32 v47, v47, v63
  v_add_f32 v32, v32, v40
  v_add_f32 v33, v33, v41
  v_add_f32 v34, v34, v42
  v_add_f32 v35, v35, v43
  v_add_f32 v36, v36, v44
  v_add_f32 v37, v37, v45
  v_add_f32 v38, v38, v46
  v_add_f32 v39, v39, v47
  v_add_f32 v32, v32, v36
  v_add_f32 v33, v33, v37
  v_add_f32 v34, v34, v38
  v_add_f32 v35, v35, v39
  v_add_f32 v32, v32, v34
  v_add_f32 v33, v33, v35
  v_cvt_pk_bf16_f32 v32, v32, v32
  v_and_b32 v32, s35, v32
  v_cvt_pk_bf16_f32 v33, v33, v33
  v_and_b32 v33, s35, v33
  v_lshlrev_b32 v34, 16, v24
  v_and_b32 v35, s35, v24
  v_add_f32 v32, v32, v34
  v_add_f32 v33, v33, v35
  v_cvt_pk_bf16_f32 v32, v32, v33
  buffer_store_dword v32, v119, s[36:39], s3 offen
  s_mov_b64 exec, -1
K1_END2:
K1_END:
  s_endpgm
.section .rodata,"a"
.p2align 6
.amdhsa_kernel sequential_preLN__mha_block_cached__swiglu_ffn__decode_kernel
  .amdhsa_next_free_vgpr 128
  .amdhsa_next_free_sgpr 96
  .amdhsa_accum_offset 128
  .amdhsa_group_segment_fixed_size 0
  .amdhsa_kernarg_size 96
  .amdhsa_user_sgpr_count 2
  .amdhsa_user_sgpr_kernarg_segment_ptr 1
  .amdhsa_system_sgpr_workgroup_id_x 1
  .amdhsa_float_denorm_mode_32 3
.end_amdhsa_kernel
```
